```python
import torch

def _softmax(x, axis=-1):
    return torch.softmax(x, dim=axis)
def _gelu(x):
    return torch.nn.functional.gelu(x, approximate="tanh")
def _silu(x):
    return torch.nn.functional.silu(x)
def _sigmoid(x):
    return torch.sigmoid(x)
def _layernorm(x, axis=-1, eps=1e-5):
    m = x.mean(dim=axis, keepdim=True)
    v = x.var(dim=axis, keepdim=True, unbiased=False)
    return (x - m) / torch.sqrt(v + eps)
def _scatter_add(tgt, idx, src, axis=0):
    return tgt.clone().index_add_(axis, idx, src)
def _segment_sum(src, seg, n):
    out = torch.zeros((n,) + src.shape[1:], dtype=src.dtype)
    return out.index_add_(0, seg, src)
def _pad(x, pw):
    flat = tuple(v for pair in reversed(pw) for v in pair)
    return torch.nn.functional.pad(x, flat)

kernel_name = 'interleave_layers__mha_block__dense_activation_gelu__prompt'

def setup_inputs():

    _w = (lambda a: (lambda t: t.to(torch.bfloat16) if t.is_floating_point() else t)(torch.as_tensor(a)))
    def _A_setup():
        B, S, D, H = 1, 2048, 448, 16
        return {
            "x": _w((lambda *s: torch.randn(*s, dtype=torch.bfloat16) * 0.05)(B, S, D)),
            "wqkv": _w((lambda *s: torch.randn(*s, dtype=torch.bfloat16) * 0.05)(D, 3 * D)),
            "wo": _w((lambda *s: torch.randn(*s, dtype=torch.bfloat16) * 0.05)(D, D)),
        }
    _A_in = _A_setup()

    def _B_setup():
        B, S, D, F = 1, 2048, 448, 1792
        return {
            "x": _w((lambda *s: torch.randn(*s, dtype=torch.bfloat16) * 0.05)(B, S, D)),
            "w1": _w((lambda *s: torch.randn(*s, dtype=torch.bfloat16) * 0.8)(D, F) * (D ** -0.5)),
            "b1": _w((lambda *s: torch.randn(*s, dtype=torch.bfloat16) * 12.8)(F) * 0.01),
            "w2": _w((lambda *s: torch.randn(*s, dtype=torch.bfloat16) * 0.2)(F, D) * (F ** -0.5)),
            "b2": _w((lambda *s: torch.randn(*s, dtype=torch.bfloat16) * 1.6)(D) * 0.01),
        }
    _B_in = _B_setup()

    return {
        "A_x": _A_in["x"],
        "A_wqkv": _A_in["wqkv"],
        "A_wo": _A_in["wo"],
        "B_x": _B_in["x"],
        "B_w1": _B_in["w1"],
        "B_b1": _B_in["b1"],
        "B_w2": _B_in["w2"],
        "B_b2": _B_in["b2"],
    }

def reference(A_x, A_wqkv, A_wo, B_x, B_w1, B_b1, B_w2, B_b2):
    def _A_ref(x, wqkv, wo):
        B, S, D = x.shape
        H = 16
        Dh = D // H
        qkv = (lambda x, *d: x.permute(*d))((x @ wqkv).reshape(B, S, 3, H, Dh), 2, 0, 3, 1, 4)
        q, k, v = qkv[0], qkv[1], qkv[2]
        scores = torch.einsum("bhqd,bhkd->bhqk", q, k) * (Dh ** -0.5)
        p = _softmax(scores, axis=-1)
        o = torch.einsum("bhqk,bhkd->bhqd", p, v)
        return (lambda x, *d: x.permute(*d))(o, 0, 2, 1, 3).reshape(B, S, D) @ wo

    def _B_ref(x, w1, b1, w2, b2):
        h = torch.einsum("bsd,df->bsf", x, w1) + b1
        h = _gelu(h)
        return torch.einsum("bsf,fd->bsd", h, w2) + b2

    x = A_x
    x = x + _A_ref(_layernorm(x, axis=-1), A_wqkv, A_wo)
    x = x + _B_ref(_layernorm(x, axis=-1), B_w1, B_b1, B_w2, B_b2)
    x = x + _A_ref(_layernorm(x, axis=-1), A_wqkv, A_wo)
    x = x + _B_ref(_layernorm(x, axis=-1), B_w1, B_b1, B_w2, B_b2)
    return x
```

```asm
; @launch grid=(256,1,1) block=(256,1,1) lds=163840
.amdgcn_target "amdgcn-amd-amdhsa--gfx950"
.text
.globl interleave_layers__mha_block__dense_activation_gelu__prompt_kernel
.p2align 8
.type interleave_layers__mha_block__dense_activation_gelu__prompt_kernel,@function
interleave_layers__mha_block__dense_activation_gelu__prompt_kernel:
KSTART:
  s_cmp_ge_u32 s2, 256
  s_cbranch_scc1 L_end
  s_load_dwordx16 s[28:43], s[0:1], 0
  s_load_dwordx4 s[44:47], s[0:1], 64
  s_load_dwordx2 s[48:49], s[0:1], 80
  v_and_b32 v1, 63, v0
  v_lshrrev_b32 v5, 6, v0
  s_nop 0
  v_readfirstlane_b32 s20, v5
  v_lshlrev_b32 v3, 4, v1
  s_lshr_b32 s22, s2, 3
  s_getpc_b64 s[4:5]
L_pc:
  s_sub_u32 s4, s4, L_pc-KSTART
  s_subb_u32 s5, s5, 0
  s_and_b32 s5, s5, 0xffff
  s_mov_b32 s6, KEND-KSTART
  s_mov_b32 s7, 0x20000
  s_lshl_b32 s25, s22, 2
  s_add_u32 s25, s25, s20
  s_mul_i32 s25, s25, 1024
  buffer_load_dword v252, v3, s[4:7], s25 offen
  v_lshrrev_b32 v2, 5, v1
  v_and_b32 v4, 31, v1
  s_and_b32 s21, s2, 7
  s_mov_b32 s3, 0
  s_lshl_b32 s64, s21, 2
  s_and_b32 s25, s22, 3
  s_add_u32 s64, s64, s25
  s_lshr_b32 s61, s22, 2
  s_lshr_b32 s60, s64, 1
  s_lshl_b32 s62, s64, 1
  s_lshr_b32 s25, s20, 1
  s_add_u32 s62, s62, s25
  s_lshl_b32 s63, s61, 1
  s_and_b32 s25, s20, 1
  s_add_u32 s63, s63, s25
  v_mul_u32_u24 v5, 896, v4
  v_lshl_add_u32 v5, v2, 4, v5
  s_mul_i32 s27, s62, 28672
  s_waitcnt lgkmcnt(0)
  s_cmp_eq_u32 s2, 255
  s_cbranch_scc0 L_noz
  s_cmp_eq_u32 s20, 0
  s_cbranch_scc0 L_noz
  s_add_u32 s52, s48, 41680896
  s_addc_u32 s53, s49, 0
  s_and_b32 s53, s53, 0xffff
  s_mov_b32 s54, 40960
  s_mov_b32 s55, 0x20000
  v_lshlrev_b32 v16, 8, v1
  v_mov_b32 v17, 0
  buffer_store_dword v17, v16, s[52:55], 0 offen sc1
  v_add_u32 v18, 16384, v16
  buffer_store_dword v17, v18, s[52:55], 0 offen sc1
  v_add_u32 v18, 32768, v16
  buffer_store_dword v17, v18, s[52:55], 0 offen sc1
  s_waitcnt vmcnt(0)
  s_add_u32 s16, s46, 0
  s_addc_u32 s17, s47, 0
  s_and_b32 s17, s17, 0xffff
  s_mov_b32 s18, 256
  s_mov_b32 s19, 0x20000
  v_mov_b32 v16, 0
  v_mov_b32 v17, 1
  s_mov_b64 exec, 1
  buffer_store_dword v17, v16, s[16:19], 0 offen sc1
  s_mov_b64 exec, -1
L_noz:
  s_add_u32 s8, s28, s27
  s_addc_u32 s9, s29, 0
  s_and_b32 s9, s9, 0xffff
  s_mov_b32 s10, 28672
  s_mov_b32 s11, 0x20000
  s_lshl_b32 s25, s63, 6
  s_cmp_lt_u32 s61, 7
  s_cselect_b32 s10, s10, 0
  buffer_load_dwordx4 v[12:15], v5, s[8:11], s25 offen
  buffer_load_dwordx4 v[16:19], v5, s[8:11], s25 offen offset:32
  s_lshr_b32 s23, s21, 1
  s_and_b32 s24, s21, 1
  s_add_u32 s84, s30, 0
  s_addc_u32 s85, s31, 0
  s_and_b32 s85, s85, 0xffff
  s_mov_b32 s86, 1204224
  s_mov_b32 s87, 0x20000
  v_mul_u32_u24 v5, 896, v2
  v_lshl_add_u32 v5, v4, 4, v5
  s_mul_i32 s25, s24, 448
  s_mul_i32 s26, s22, 37632
  s_add_u32 s25, s25, s26
  s_mul_i32 s26, s20, 1792
  s_add_u32 s25, s25, s26
  buffer_load_dwordx4 v[248:251], v5, s[84:87], s25 offen
  s_add_u32 s25, s25, 7168
  buffer_load_dwordx4 v[248:251], v5, s[84:87], s25 offen
  s_add_u32 s25, s25, 7168
  buffer_load_dwordx4 v[248:251], v5, s[84:87], s25 offen
  s_add_u32 s25, s25, 7168
  buffer_load_dwordx4 v[248:251], v5, s[84:87], s25 offen
  s_add_u32 s25, s25, 7168
  buffer_load_dwordx4 v[248:251], v5, s[84:87], s25 offen
  s_add_u32 s25, s25, 7168
  buffer_load_dwordx4 v[248:251], v5, s[84:87], s25 offen
  s_lshl_b32 s27, s2, 2
  s_add_u32 s27, s27, s20
  s_lshl_b32 s27, s27, 10
  s_add_u32 s84, s32, 0
  s_addc_u32 s85, s33, 0
  s_and_b32 s85, s85, 0xffff
  s_mov_b32 s86, 401408
  s_mov_b32 s87, 0x20000
  buffer_load_dwordx4 v[248:251], v3, s[84:87], s27 offen
  s_add_u32 s84, s36, 0
  s_addc_u32 s85, s37, 0
  s_and_b32 s85, s85, 0xffff
  s_mov_b32 s86, 1605632
  s_mov_b32 s87, 0x20000
  buffer_load_dwordx4 v[248:251], v3, s[84:87], s27 offen
  s_add_u32 s26, s27, 1048576
  buffer_load_dwordx4 v[248:251], v3, s[84:87], s26 offen
  s_add_u32 s84, s40, 0
  s_addc_u32 s85, s41, 0
  s_and_b32 s85, s85, 0xffff
  s_mov_b32 s86, 1605632
  s_mov_b32 s87, 0x20000
  buffer_load_dwordx4 v[248:251], v3, s[84:87], s27 offen
  s_add_u32 s26, s27, 1048576
  buffer_load_dwordx4 v[248:251], v3, s[84:87], s26 offen
  v_mov_b32 v10, 0
  s_mov_b32 s50, 0
  s_mov_b32 s51, -1
  s_mov_b32 s56, 0x3f803f80
  s_mov_b32 s72, 0
  s_add_u32 s52, s48, 41680896
  s_addc_u32 s53, s49, 0
  s_and_b32 s53, s53, 0xffff
  s_mov_b32 s54, 40960
  s_mov_b32 s55, 0x20000
  s_getreg_b32 s90, hwreg(HW_REG_XCC_ID, 0, 4)
  s_and_b32 s90, s90, 7
  s_cmp_eq_u32 s20, 0
  s_cbranch_scc0 L_notk
  s_add_u32 s16, s46, 0
  s_addc_u32 s17, s47, 0
  s_and_b32 s17, s17, 0xffff
  s_mov_b32 s18, 256
  s_mov_b32 s19, 0x20000
  s_lshl_b32 s25, s90, 2
  s_add_u32 s25, s25, 128
  v_mov_b32 v5, s25
  v_mov_b32 v11, 1
  s_mov_b64 exec, 1
  buffer_atomic_add v11, v5, s[16:19], 0 offen sc0
  s_mov_b64 exec, -1
L_notk:
  s_mov_b32 s84, s60
  s_mov_b32 s85, s61
  s_lshl_b32 s60, s23, 2
  s_and_b32 s25, s22, 3
  s_add_u32 s60, s60, s25
  s_lshl_b32 s61, s24, 3
  s_lshr_b32 s25, s22, 2
  s_add_u32 s61, s61, s25
  v_lshrrev_b32 v5, 4, v1
  v_and_b32 v6, 15, v1
  v_lshlrev_b32 v7, 2, v5
  v_xor_b32 v6, v6, v7
  s_mov_b32 s25, s20
  s_lshl_b32 s25, s25, 2
  v_add_u32 v5, s25, v5
  v_mul_u32_u24 v9, 2688, v5
  v_lshrrev_b32 v7, 2, v6
  v_and_b32 v8, 3, v6
  v_lshlrev_b32 v8, 4, v8
  v_add_u32 v9, v9, v8
  v_mul_u32_u24 v8, 896, v7
  v_add_u32 v9, v9, v8
  s_mul_i32 s25, s61, 56
  v_add_u32 v9, s25, v9
  v_cmp_eq_u32 vcc, 3, v7
  v_mov_b32 v8, 0x40000000
  s_nop 0
  v_cndmask_b32 v9, v9, v8, vcc
  s_add_u32 s76, s30, 0
  s_addc_u32 s77, s31, 0
  s_and_b32 s77, s77, 0xffff
  s_mov_b32 s78, 1204224
  s_mov_b32 s79, 0x20000
  s_lshl_b32 s57, s20, 10
  s_mov_b32 s58, 0
  s_mov_b32 s60, s84
  s_mov_b32 s61, s85
  s_cmp_lt_u32 s61, 7
  s_cbranch_scc0 L_p0_skip
  s_waitcnt vmcnt(11)
  v_permlane32_swap_b32 v12, v14
  v_permlane32_swap_b32 v13, v15
  v_permlane32_swap_b32 v16, v18
  v_permlane32_swap_b32 v17, v19
  v_lshlrev_b32 v24, 16, v12
  v_and_b32 v25, 0xffff0000, v12
  v_lshlrev_b32 v26, 16, v13
  v_and_b32 v27, 0xffff0000, v13
  v_lshlrev_b32 v28, 16, v14
  v_and_b32 v29, 0xffff0000, v14
  v_lshlrev_b32 v30, 16, v15
  v_and_b32 v31, 0xffff0000, v15
  v_lshlrev_b32 v32, 16, v16
  v_and_b32 v33, 0xffff0000, v16
  v_lshlrev_b32 v34, 16, v17
  v_and_b32 v35, 0xffff0000, v17
  v_lshlrev_b32 v36, 16, v18
  v_and_b32 v37, 0xffff0000, v18
  v_lshlrev_b32 v38, 16, v19
  v_and_b32 v39, 0xffff0000, v19
  s_mov_b32 s74, 38797312
  s_mov_b32 s75, 41156608
  v_cvt_pk_bf16_f32 v44, v24, v25
  v_cvt_pk_bf16_f32 v45, v26, v27
  v_cvt_pk_bf16_f32 v46, v28, v29
  v_cvt_pk_bf16_f32 v47, v30, v31
  v_cvt_pk_bf16_f32 v48, v32, v33
  v_cvt_pk_bf16_f32 v49, v34, v35
  v_cvt_pk_bf16_f32 v50, v36, v37
  v_cvt_pk_bf16_f32 v51, v38, v39
  s_mul_i32 s25, s62, 28672
  s_add_u32 s25, s25, s74
  s_add_u32 s12, s48, s25
  s_addc_u32 s13, s49, 0
  s_and_b32 s13, s13, 0xffff
  s_mov_b32 s14, 28672
  s_mov_b32 s15, 0x20000
  s_lshl_b32 s25, s63, 11
  buffer_store_dwordx4 v[44:47], v3, s[12:15], s25 offen sc1
  buffer_store_dwordx4 v[48:51], v3, s[12:15], s25 offen offset:1024 sc1
  v_pk_add_f32 v[40:41], v[24:25], v[26:27]
  v_pk_mul_f32 v[42:43], v[24:25], v[24:25]
  v_pk_fma_f32 v[42:43], v[26:27], v[26:27], v[42:43]
  v_pk_add_f32 v[40:41], v[40:41], v[28:29]
  v_pk_fma_f32 v[42:43], v[28:29], v[28:29], v[42:43]
  v_pk_add_f32 v[40:41], v[40:41], v[30:31]
  v_pk_fma_f32 v[42:43], v[30:31], v[30:31], v[42:43]
  v_pk_add_f32 v[40:41], v[40:41], v[32:33]
  v_pk_fma_f32 v[42:43], v[32:33], v[32:33], v[42:43]
  v_pk_add_f32 v[40:41], v[40:41], v[34:35]
  v_pk_fma_f32 v[42:43], v[34:35], v[34:35], v[42:43]
  v_pk_add_f32 v[40:41], v[40:41], v[36:37]
  v_pk_fma_f32 v[42:43], v[36:37], v[36:37], v[42:43]
  v_pk_add_f32 v[40:41], v[40:41], v[38:39]
  v_pk_fma_f32 v[42:43], v[38:39], v[38:39], v[42:43]
  v_add_f32 v52, v40, v41
  v_add_f32 v53, v42, v43
  v_mov_b32 v5, v52
  s_nop 1
  v_permlane32_swap_b32 v52, v5
  v_add_f32 v52, v52, v5
  v_mov_b32 v6, v53
  s_nop 1
  v_permlane32_swap_b32 v53, v6
  v_add_f32 v53, v53, v6
  s_mul_i32 s25, s62, 14
  s_add_u32 s25, s25, s63
  s_lshl_b32 s25, s25, 8
  s_add_u32 s25, s25, s75
  s_add_u32 s16, s48, s25
  s_addc_u32 s17, s49, 0
  s_and_b32 s17, s17, 0xffff
  s_mov_b32 s18, 256
  s_mov_b32 s19, 0x20000
  v_lshlrev_b32 v5, 3, v4
  buffer_store_dwordx2 v[52:53], v5, s[16:19], 0 offen sc1
  s_add_u32 s16, s46, 0
  s_addc_u32 s17, s47, 0
  s_and_b32 s17, s17, 0xffff
  s_mov_b32 s18, 256
  s_mov_b32 s19, 0x20000
  v_mov_b32 v7, 0
  buffer_load_dword v8, v7, s[16:19], 0 offen sc1
  s_waitcnt vmcnt(0)
  s_barrier
  s_cmp_eq_u32 s20, 0
  s_cbranch_scc0 L_sig_1
  v_readfirstlane_b32 s25, v8
  s_nop 0
  s_cmp_lg_u32 s25, 0
  s_cbranch_scc1 L_gok_2
  s_add_u32 s16, s46, 0
  s_addc_u32 s17, s47, 0
  s_and_b32 s17, s17, 0xffff
  s_mov_b32 s18, 256
  s_mov_b32 s19, 0x20000
  v_mov_b32 v7, 0
  s_mov_b32 s26, 0
L_gl_4:
  buffer_load_dword v8, v7, s[16:19], 0 offen sc1
  s_waitcnt vmcnt(0)
  v_readfirstlane_b32 s25, v8
  s_add_u32 s26, s26, 1
  s_cmp_gt_u32 s26, 20000
  s_cbranch_scc1 L_go_3
  s_cmp_eq_u32 s25, 0
  s_cbranch_scc1 L_gl_4
L_go_3:
L_gok_2:
  s_xor_b32 s25, s3, 1
  s_mul_i32 s25, s25, 80
  s_add_u32 s25, s25, 64
  s_add_u32 s25, s25, s60
  s_lshl_b32 s25, s25, 8
  v_mov_b32 v5, s25
  v_mov_b32 v6, 1
  s_mov_b64 exec, 1
  buffer_atomic_add v6, v5, s[52:55], 0 offen sc1
  s_mov_b64 exec, -1
L_sig_1:
  s_add_u32 m0, s57, 0
  s_mov_b32 s58, 0
  buffer_load_dwordx4 v9, s[76:79], s58 offen lds
  s_add_u32 m0, s57, 4096
  s_mov_b32 s58, 43008
  buffer_load_dwordx4 v9, s[76:79], s58 offen lds
  s_add_u32 m0, s57, 8192
  s_mov_b32 s58, 86016
  buffer_load_dwordx4 v9, s[76:79], s58 offen lds
  s_add_u32 m0, s57, 12288
  s_mov_b32 s58, 129024
  buffer_load_dwordx4 v9, s[76:79], s58 offen lds
  s_add_u32 m0, s57, 16384
  s_mov_b32 s58, 172032
  buffer_load_dwordx4 v9, s[76:79], s58 offen lds
  s_add_u32 m0, s57, 20480
  s_mov_b32 s58, 215040
  buffer_load_dwordx4 v9, s[76:79], s58 offen lds
  s_add_u32 m0, s57, 24576
  s_mov_b32 s58, 258048
  buffer_load_dwordx4 v9, s[76:79], s58 offen lds
  s_add_u32 m0, s57, 28672
  s_mov_b32 s58, 301056
  buffer_load_dwordx4 v9, s[76:79], s58 offen lds
  s_add_u32 m0, s57, 32768
  s_mov_b32 s58, 344064
  buffer_load_dwordx4 v9, s[76:79], s58 offen lds
  s_add_u32 m0, s57, 36864
  s_mov_b32 s58, 387072
  buffer_load_dwordx4 v9, s[76:79], s58 offen lds
  s_add_u32 m0, s57, 40960
  s_mov_b32 s58, 430080
  buffer_load_dwordx4 v9, s[76:79], s58 offen lds
  s_add_u32 m0, s57, 45056
  s_mov_b32 s58, 473088
  buffer_load_dwordx4 v9, s[76:79], s58 offen lds
  s_add_u32 m0, s57, 49152
  s_mov_b32 s58, 516096
  buffer_load_dwordx4 v9, s[76:79], s58 offen lds
  s_add_u32 m0, s57, 53248
  s_mov_b32 s58, 559104
  buffer_load_dwordx4 v9, s[76:79], s58 offen lds
  s_add_u32 m0, s57, 57344
  s_mov_b32 s58, 602112
  buffer_load_dwordx4 v9, s[76:79], s58 offen lds
  s_add_u32 m0, s57, 61440
  s_mov_b32 s58, 645120
  buffer_load_dwordx4 v9, s[76:79], s58 offen lds
  s_add_u32 m0, s57, 65536
  s_mov_b32 s58, 688128
  buffer_load_dwordx4 v9, s[76:79], s58 offen lds
  s_add_u32 m0, s57, 69632
  s_mov_b32 s58, 731136
  buffer_load_dwordx4 v9, s[76:79], s58 offen lds
  s_add_u32 m0, s57, 73728
  s_mov_b32 s58, 774144
  buffer_load_dwordx4 v9, s[76:79], s58 offen lds
  s_add_u32 m0, s57, 77824
  s_mov_b32 s58, 817152
  buffer_load_dwordx4 v9, s[76:79], s58 offen lds
  s_add_u32 m0, s57, 81920
  s_mov_b32 s58, 860160
  buffer_load_dwordx4 v9, s[76:79], s58 offen lds
  s_add_u32 m0, s57, 86016
  s_mov_b32 s58, 903168
  buffer_load_dwordx4 v9, s[76:79], s58 offen lds
  s_add_u32 m0, s57, 90112
  s_mov_b32 s58, 946176
  buffer_load_dwordx4 v9, s[76:79], s58 offen lds
  s_add_u32 m0, s57, 94208
  s_mov_b32 s58, 989184
  buffer_load_dwordx4 v9, s[76:79], s58 offen lds
  s_add_u32 m0, s57, 98304
  s_mov_b32 s58, 1032192
  buffer_load_dwordx4 v9, s[76:79], s58 offen lds
  s_add_u32 m0, s57, 102400
  s_mov_b32 s58, 1075200
  buffer_load_dwordx4 v9, s[76:79], s58 offen lds
  s_add_u32 m0, s57, 106496
  s_mov_b32 s58, 1118208
  buffer_load_dwordx4 v9, s[76:79], s58 offen lds
  s_add_u32 m0, s57, 110592
  s_mov_b32 s58, 1161216
  buffer_load_dwordx4 v9, s[76:79], s58 offen lds
  s_branch L_p0_done
L_p0_skip:
  s_add_u32 m0, s57, 0
  s_mov_b32 s58, 0
  buffer_load_dwordx4 v9, s[76:79], s58 offen lds
  s_add_u32 m0, s57, 4096
  s_mov_b32 s58, 43008
  buffer_load_dwordx4 v9, s[76:79], s58 offen lds
  s_add_u32 m0, s57, 8192
  s_mov_b32 s58, 86016
  buffer_load_dwordx4 v9, s[76:79], s58 offen lds
  s_add_u32 m0, s57, 12288
  s_mov_b32 s58, 129024
  buffer_load_dwordx4 v9, s[76:79], s58 offen lds
  s_add_u32 m0, s57, 16384
  s_mov_b32 s58, 172032
  buffer_load_dwordx4 v9, s[76:79], s58 offen lds
  s_add_u32 m0, s57, 20480
  s_mov_b32 s58, 215040
  buffer_load_dwordx4 v9, s[76:79], s58 offen lds
  s_add_u32 m0, s57, 24576
  s_mov_b32 s58, 258048
  buffer_load_dwordx4 v9, s[76:79], s58 offen lds
  s_add_u32 m0, s57, 28672
  s_mov_b32 s58, 301056
  buffer_load_dwordx4 v9, s[76:79], s58 offen lds
  s_add_u32 m0, s57, 32768
  s_mov_b32 s58, 344064
  buffer_load_dwordx4 v9, s[76:79], s58 offen lds
  s_add_u32 m0, s57, 36864
  s_mov_b32 s58, 387072
  buffer_load_dwordx4 v9, s[76:79], s58 offen lds
  s_add_u32 m0, s57, 40960
  s_mov_b32 s58, 430080
  buffer_load_dwordx4 v9, s[76:79], s58 offen lds
  s_add_u32 m0, s57, 45056
  s_mov_b32 s58, 473088
  buffer_load_dwordx4 v9, s[76:79], s58 offen lds
  s_add_u32 m0, s57, 49152
  s_mov_b32 s58, 516096
  buffer_load_dwordx4 v9, s[76:79], s58 offen lds
  s_add_u32 m0, s57, 53248
  s_mov_b32 s58, 559104
  buffer_load_dwordx4 v9, s[76:79], s58 offen lds
  s_add_u32 m0, s57, 57344
  s_mov_b32 s58, 602112
  buffer_load_dwordx4 v9, s[76:79], s58 offen lds
  s_add_u32 m0, s57, 61440
  s_mov_b32 s58, 645120
  buffer_load_dwordx4 v9, s[76:79], s58 offen lds
  s_add_u32 m0, s57, 65536
  s_mov_b32 s58, 688128
  buffer_load_dwordx4 v9, s[76:79], s58 offen lds
  s_add_u32 m0, s57, 69632
  s_mov_b32 s58, 731136
  buffer_load_dwordx4 v9, s[76:79], s58 offen lds
  s_add_u32 m0, s57, 73728
  s_mov_b32 s58, 774144
  buffer_load_dwordx4 v9, s[76:79], s58 offen lds
  s_add_u32 m0, s57, 77824
  s_mov_b32 s58, 817152
  buffer_load_dwordx4 v9, s[76:79], s58 offen lds
  s_add_u32 m0, s57, 81920
  s_mov_b32 s58, 860160
  buffer_load_dwordx4 v9, s[76:79], s58 offen lds
  s_add_u32 m0, s57, 86016
  s_mov_b32 s58, 903168
  buffer_load_dwordx4 v9, s[76:79], s58 offen lds
  s_add_u32 m0, s57, 90112
  s_mov_b32 s58, 946176
  buffer_load_dwordx4 v9, s[76:79], s58 offen lds
  s_add_u32 m0, s57, 94208
  s_mov_b32 s58, 989184
  buffer_load_dwordx4 v9, s[76:79], s58 offen lds
  s_add_u32 m0, s57, 98304
  s_mov_b32 s58, 1032192
  buffer_load_dwordx4 v9, s[76:79], s58 offen lds
  s_add_u32 m0, s57, 102400
  s_mov_b32 s58, 1075200
  buffer_load_dwordx4 v9, s[76:79], s58 offen lds
  s_add_u32 m0, s57, 106496
  s_mov_b32 s58, 1118208
  buffer_load_dwordx4 v9, s[76:79], s58 offen lds
  s_add_u32 m0, s57, 110592
  s_mov_b32 s58, 1161216
  buffer_load_dwordx4 v9, s[76:79], s58 offen lds
  s_cmp_eq_u32 s20, 0
  s_cbranch_scc0 L_go_5
  s_add_u32 s16, s46, 0
  s_addc_u32 s17, s47, 0
  s_and_b32 s17, s17, 0xffff
  s_mov_b32 s18, 256
  s_mov_b32 s19, 0x20000
  v_mov_b32 v7, 0
  s_mov_b32 s26, 0
L_gl_6:
  buffer_load_dword v8, v7, s[16:19], 0 offen sc1
  s_waitcnt vmcnt(0)
  v_readfirstlane_b32 s25, v8
  s_add_u32 s26, s26, 1
  s_cmp_gt_u32 s26, 20000
  s_cbranch_scc1 L_go_5
  s_cmp_eq_u32 s25, 0
  s_cbranch_scc1 L_gl_6
L_go_5:
  s_barrier
L_p0_done:
  s_lshl_b32 s60, s23, 2
  s_and_b32 s25, s22, 3
  s_add_u32 s60, s60, s25
  s_lshl_b32 s61, s24, 3
  s_lshr_b32 s25, s22, 2
  s_add_u32 s61, s61, s25
L_qkv:
  s_lshl_b32 s62, s60, 2
  s_add_u32 s62, s62, s20
  s_sub_u32 s26, 20971520, s72
  s_mul_i32 s27, s62, 28672
  s_add_u32 s27, s27, s26
  s_add_u32 s27, s27, 17825792
  s_add_u32 s4, s48, s27
  s_addc_u32 s5, s49, 0
  s_and_b32 s5, s5, 0xffff
  s_mov_b32 s6, 28672
  s_mov_b32 s7, 0x20000
  s_mul_i32 s27, s62, 3584
  s_add_u32 s27, s27, s26
  s_add_u32 s27, s27, 20185088
  s_add_u32 s8, s48, s27
  s_addc_u32 s9, s49, 0
  s_and_b32 s9, s9, 0xffff
  s_mov_b32 s10, 3584
  s_mov_b32 s11, 0x20000
  s_mov_b32 s74, 0
  v_mov_b32 v12, v3
  s_mov_b32 s75, 1024
  v_bfe_u32 v5, v1, 2, 2
  v_lshlrev_b32 v6, 2, v2
  v_add_u32 v6, v6, v5
  v_lshlrev_b32 v6, 8, v6
  v_and_b32 v7, 3, v1
  v_lshlrev_b32 v7, 3, v7
  v_add_u32 v6, v6, v7
  v_bfe_u32 v7, v1, 4, 1
  v_lshlrev_b32 v7, 5, v7
  v_add_u32 v6, v6, v7
  v_xor_b32 v7, 0, v5
  v_lshlrev_b32 v7, 6, v7
  v_add_u32 v13, v6, v7
  v_xor_b32 v7, 1, v5
  v_lshlrev_b32 v7, 6, v7
  v_add_u32 v14, v6, v7
  v_xor_b32 v7, 2, v5
  v_lshlrev_b32 v7, 6, v7
  v_add_u32 v15, v6, v7
  v_xor_b32 v7, s20, v5
  v_lshlrev_b32 v7, 6, v7
  v_add_u32 v8, v6, v7
  s_mul_i32 s27, s61, 384
  s_add_u32 s27, s27, 20447232
  s_add_u32 s16, s48, s27
  s_addc_u32 s17, s49, 0
  s_and_b32 s17, s17, 0xffff
  s_mov_b32 s18, 384
  s_mov_b32 s19, 0x20000
  s_cmp_eq_u32 s3, 0
  s_cbranch_scc0 L_qkv_l1
  s_waitcnt vmcnt(0)
  s_barrier
  s_cmp_eq_u32 s20, 0
  s_cbranch_scc0 L_wt_7
  s_xor_b32 s25, s3, 1
  s_mul_i32 s25, s25, 80
  s_add_u32 s25, s25, 64
  s_add_u32 s25, s25, s60
  s_lshl_b32 s25, s25, 8
  v_mov_b32 v5, s25
  s_mov_b32 s26, 0
L_sp_8:
  buffer_load_dword v6, v5, s[52:55], 0 offen sc1
  s_waitcnt vmcnt(0)
  v_readfirstlane_b32 s25, v6
  s_add_u32 s26, s26, 1
  s_cmp_gt_u32 s26, 20000
  s_cbranch_scc1 L_wt_7x
  s_cmp_lt_u32 s25, 14
  s_cbranch_scc1 L_sp_8
L_wt_7x:
L_wt_7:
  s_barrier
  buffer_load_dwordx4 v[36:39], v12, s[4:7], s74 offen sc1
  s_add_u32 s74, s74, s75
  buffer_load_dwordx4 v[40:43], v12, s[4:7], s74 offen sc1
  s_add_u32 s74, s74, s75
  buffer_load_dwordx4 v[44:47], v12, s[4:7], s74 offen sc1
  s_add_u32 s74, s74, s75
  buffer_load_dwordx4 v[48:51], v12, s[4:7], s74 offen sc1
  s_add_u32 s74, s74, s75
  buffer_load_dwordx4 v[52:55], v12, s[4:7], s74 offen sc1
  s_add_u32 s74, s74, s75
  buffer_load_dwordx4 v[56:59], v12, s[4:7], s74 offen sc1
  s_add_u32 s74, s74, s75
  buffer_load_dwordx4 v[60:63], v12, s[4:7], s74 offen sc1
  s_add_u32 s74, s74, s75
  buffer_load_dwordx4 v[64:67], v12, s[4:7], s74 offen sc1
  s_add_u32 s74, s74, s75
  v_mov_b32 v184, v8
  v_mov_b32 v180, 0
  v_mov_b32 v181, 0
  v_mov_b32 v182, 0
  v_mov_b32 v183, 0
  s_mov_b32 s67, 0
L_cs_9:
  ds_read_b64_tr_b16 v[188:189], v184 offset:0
  ds_read_b64_tr_b16 v[190:191], v184 offset:2048
  ds_read_b64_tr_b16 v[192:193], v184 offset:4096
  ds_read_b64_tr_b16 v[194:195], v184 offset:6144
  ds_read_b64_tr_b16 v[196:197], v184 offset:8192
  ds_read_b64_tr_b16 v[198:199], v184 offset:10240
  ds_read_b64_tr_b16 v[200:201], v184 offset:12288
  ds_read_b64_tr_b16 v[202:203], v184 offset:14336
  v_add_u32 v184, 16384, v184
  s_waitcnt lgkmcnt(6)
  v_dot2c_f32_bf16 v180, s56, v188
  v_dot2c_f32_bf16 v181, s56, v189
  v_dot2c_f32_bf16 v182, s56, v190
  v_dot2c_f32_bf16 v183, s56, v191
  s_waitcnt lgkmcnt(4)
  v_dot2c_f32_bf16 v180, s56, v192
  v_dot2c_f32_bf16 v181, s56, v193
  v_dot2c_f32_bf16 v182, s56, v194
  v_dot2c_f32_bf16 v183, s56, v195
  s_waitcnt lgkmcnt(2)
  v_dot2c_f32_bf16 v180, s56, v196
  v_dot2c_f32_bf16 v181, s56, v197
  v_dot2c_f32_bf16 v182, s56, v198
  v_dot2c_f32_bf16 v183, s56, v199
  s_waitcnt lgkmcnt(0)
  v_dot2c_f32_bf16 v180, s56, v200
  v_dot2c_f32_bf16 v181, s56, v201
  v_dot2c_f32_bf16 v182, s56, v202
  v_dot2c_f32_bf16 v183, s56, v203
  s_add_u32 s67, s67, 1
  s_cmp_lt_u32 s67, 7
  s_cbranch_scc1 L_cs_9
  v_add_f32 v180, v180, v181
  v_add_f32 v182, v182, v183
  v_add_f32 v180, v180, v182
  v_mov_b32 v181, v180
  s_nop 1
  v_permlane32_swap_b32 v180, v181
  v_add_f32 v180, v180, v181
  s_lshl_b32 s25, s20, 7
  s_add_u32 s25, s25, 162816
  v_lshl_add_u32 v184, v4, 2, s25
  ds_write_b32 v184, v180
  s_waitcnt lgkmcnt(0)
  s_lshl_b32 s25, s20, 7
  v_lshl_add_u32 v5, v4, 2, s25
  buffer_store_dword v180, v5, s[16:19], 0 offen sc1
  s_cmp_lt_u32 s60, 14
  s_cbranch_scc0 L_nd_10
  s_lshl_b32 s25, s60, 13
  s_lshl_b32 s26, s20, 11
  s_add_u32 s25, s25, s26
  v_add_u32 v5, s25, v3
  ds_read_b128 v[228:231], v5
  ds_read_b128 v[232:235], v5 offset:1024
  s_mul_i32 s26, s61, 114688
  s_add_u32 s26, s26, 41943040
  s_add_u32 s16, s48, s26
  s_addc_u32 s17, s49, 0
  s_and_b32 s17, s17, 0xffff
  s_mov_b32 s18, 114688
  s_mov_b32 s19, 0x20000
  s_waitcnt lgkmcnt(0)
  buffer_store_dwordx4 v[228:231], v3, s[16:19], s25 offen sc1
  buffer_store_dwordx4 v[232:235], v3, s[16:19], s25 offen offset:1024 sc1
L_nd_10:
  s_branch L_qkv_go
L_qkv_l1:
  v_lshlrev_b32 v5, 2, v4
  buffer_load_dword v19, v5, s[16:19], 0 offen offset:0 sc1
  buffer_load_dword v20, v5, s[16:19], 0 offen offset:128 sc1
  buffer_load_dword v21, v5, s[16:19], 0 offen offset:256 sc1
  s_cmp_eq_u32 s20, 0
  s_cbranch_scc0 L_wt_11
  s_xor_b32 s25, s3, 1
  s_mul_i32 s25, s25, 80
  s_add_u32 s25, s25, 64
  s_add_u32 s25, s25, s60
  s_lshl_b32 s25, s25, 8
  v_mov_b32 v5, s25
  s_mov_b32 s26, 0
L_sp_12:
  buffer_load_dword v6, v5, s[52:55], 0 offen sc1
  s_waitcnt vmcnt(0)
  v_readfirstlane_b32 s25, v6
  s_add_u32 s26, s26, 1
  s_cmp_gt_u32 s26, 20000
  s_cbranch_scc1 L_wt_11x
  s_cmp_lt_u32 s25, 14
  s_cbranch_scc1 L_sp_12
L_wt_11x:
L_wt_11:
  s_barrier
  buffer_load_dwordx4 v[36:39], v12, s[4:7], s74 offen sc1
  s_add_u32 s74, s74, s75
  buffer_load_dwordx4 v[40:43], v12, s[4:7], s74 offen sc1
  s_add_u32 s74, s74, s75
  buffer_load_dwordx4 v[44:47], v12, s[4:7], s74 offen sc1
  s_add_u32 s74, s74, s75
  buffer_load_dwordx4 v[48:51], v12, s[4:7], s74 offen sc1
  s_add_u32 s74, s74, s75
  buffer_load_dwordx4 v[52:55], v12, s[4:7], s74 offen sc1
  s_add_u32 s74, s74, s75
  buffer_load_dwordx4 v[56:59], v12, s[4:7], s74 offen sc1
  s_add_u32 s74, s74, s75
  buffer_load_dwordx4 v[60:63], v12, s[4:7], s74 offen sc1
  s_add_u32 s74, s74, s75
  buffer_load_dwordx4 v[64:67], v12, s[4:7], s74 offen sc1
  s_add_u32 s74, s74, s75
  s_waitcnt vmcnt(8)
  s_barrier
L_qkv_go:
  ds_read_b64_tr_b16 v[148:149], v13 offset:0
  ds_read_b64_tr_b16 v[150:151], v13 offset:2048
  ds_read_b64_tr_b16 v[152:153], v14 offset:0
  ds_read_b64_tr_b16 v[154:155], v14 offset:2048
  ds_read_b64_tr_b16 v[156:157], v15 offset:0
  ds_read_b64_tr_b16 v[158:159], v15 offset:2048
  s_waitcnt vmcnt(7) lgkmcnt(4)
  v_mfma_f32_32x32x16_bf16 v[180:195], v[148:151], v[36:39], 0
  ds_read_b64_tr_b16 v[164:165], v13 offset:4096
  ds_read_b64_tr_b16 v[166:167], v13 offset:6144
  s_waitcnt lgkmcnt(4)
  v_mfma_f32_32x32x16_bf16 v[196:211], v[152:155], v[36:39], 0
  ds_read_b64_tr_b16 v[168:169], v14 offset:4096
  ds_read_b64_tr_b16 v[170:171], v14 offset:6144
  s_waitcnt lgkmcnt(4)
  v_mfma_f32_32x32x16_bf16 v[212:227], v[36:39], v[156:159], 0
  ds_read_b64_tr_b16 v[172:173], v15 offset:4096
  ds_read_b64_tr_b16 v[174:175], v15 offset:6144
  buffer_load_dwordx4 v[68:71], v12, s[4:7], s74 offen sc1
  s_add_u32 s74, s74, s75
  buffer_load_dwordx4 v[72:75], v12, s[4:7], s74 offen sc1
  s_add_u32 s74, s74, s75
  s_waitcnt vmcnt(8) lgkmcnt(4)
  v_mfma_f32_32x32x16_bf16 v[180:195], v[164:167], v[40:43], v[180:195]
  ds_read_b64_tr_b16 v[148:149], v13 offset:8192
  ds_read_b64_tr_b16 v[150:151], v13 offset:10240
  s_waitcnt lgkmcnt(4)
  v_mfma_f32_32x32x16_bf16 v[196:211], v[168:171], v[40:43], v[196:211]
  ds_read_b64_tr_b16 v[152:153], v14 offset:8192
  ds_read_b64_tr_b16 v[154:155], v14 offset:10240
  s_waitcnt lgkmcnt(4)
  v_mfma_f32_32x32x16_bf16 v[212:227], v[40:43], v[172:175], v[212:227]
  ds_read_b64_tr_b16 v[156:157], v15 offset:8192
  ds_read_b64_tr_b16 v[158:159], v15 offset:10240
  buffer_load_dwordx4 v[76:79], v12, s[4:7], s74 offen sc1
  s_add_u32 s74, s74, s75
  buffer_load_dwordx4 v[80:83], v12, s[4:7], s74 offen sc1
  s_add_u32 s74, s74, s75
  s_waitcnt vmcnt(9) lgkmcnt(4)
  v_mfma_f32_32x32x16_bf16 v[180:195], v[148:151], v[44:47], v[180:195]
  ds_read_b64_tr_b16 v[164:165], v13 offset:12288
  ds_read_b64_tr_b16 v[166:167], v13 offset:14336
  s_waitcnt lgkmcnt(4)
  v_mfma_f32_32x32x16_bf16 v[196:211], v[152:155], v[44:47], v[196:211]
  ds_read_b64_tr_b16 v[168:169], v14 offset:12288
  ds_read_b64_tr_b16 v[170:171], v14 offset:14336
  s_waitcnt lgkmcnt(4)
  v_mfma_f32_32x32x16_bf16 v[212:227], v[44:47], v[156:159], v[212:227]
  ds_read_b64_tr_b16 v[172:173], v15 offset:12288
  ds_read_b64_tr_b16 v[174:175], v15 offset:14336
  buffer_load_dwordx4 v[84:87], v12, s[4:7], s74 offen sc1
  s_add_u32 s74, s74, s75
  buffer_load_dwordx4 v[88:91], v12, s[4:7], s74 offen sc1
  s_add_u32 s74, s74, s75
  s_waitcnt vmcnt(10) lgkmcnt(4)
  v_mfma_f32_32x32x16_bf16 v[180:195], v[164:167], v[48:51], v[180:195]
  ds_read_b64_tr_b16 v[148:149], v13 offset:16384
  ds_read_b64_tr_b16 v[150:151], v13 offset:18432
  s_waitcnt lgkmcnt(4)
  v_mfma_f32_32x32x16_bf16 v[196:211], v[168:171], v[48:51], v[196:211]
  ds_read_b64_tr_b16 v[152:153], v14 offset:16384
  ds_read_b64_tr_b16 v[154:155], v14 offset:18432
  s_waitcnt lgkmcnt(4)
  v_mfma_f32_32x32x16_bf16 v[212:227], v[48:51], v[172:175], v[212:227]
  ds_read_b64_tr_b16 v[156:157], v15 offset:16384
  ds_read_b64_tr_b16 v[158:159], v15 offset:18432
  buffer_load_dwordx4 v[92:95], v12, s[4:7], s74 offen sc1
  s_add_u32 s74, s74, s75
  buffer_load_dwordx4 v[96:99], v12, s[4:7], s74 offen sc1
  s_add_u32 s74, s74, s75
  s_waitcnt vmcnt(11) lgkmcnt(4)
  v_mfma_f32_32x32x16_bf16 v[180:195], v[148:151], v[52:55], v[180:195]
  ds_read_b64_tr_b16 v[164:165], v13 offset:20480
  ds_read_b64_tr_b16 v[166:167], v13 offset:22528
  s_waitcnt lgkmcnt(4)
  v_mfma_f32_32x32x16_bf16 v[196:211], v[152:155], v[52:55], v[196:211]
  ds_read_b64_tr_b16 v[168:169], v14 offset:20480
  ds_read_b64_tr_b16 v[170:171], v14 offset:22528
  s_waitcnt lgkmcnt(4)
  v_mfma_f32_32x32x16_bf16 v[212:227], v[52:55], v[156:159], v[212:227]
  ds_read_b64_tr_b16 v[172:173], v15 offset:20480
  ds_read_b64_tr_b16 v[174:175], v15 offset:22528
  buffer_load_dwordx4 v[100:103], v12, s[4:7], s74 offen sc1
  s_add_u32 s74, s74, s75
  buffer_load_dwordx4 v[104:107], v12, s[4:7], s74 offen sc1
  s_add_u32 s74, s74, s75
  s_waitcnt vmcnt(12) lgkmcnt(4)
  v_mfma_f32_32x32x16_bf16 v[180:195], v[164:167], v[56:59], v[180:195]
  ds_read_b64_tr_b16 v[148:149], v13 offset:24576
  ds_read_b64_tr_b16 v[150:151], v13 offset:26624
  s_waitcnt lgkmcnt(4)
  v_mfma_f32_32x32x16_bf16 v[196:211], v[168:171], v[56:59], v[196:211]
  ds_read_b64_tr_b16 v[152:153], v14 offset:24576
  ds_read_b64_tr_b16 v[154:155], v14 offset:26624
  s_waitcnt lgkmcnt(4)
  v_mfma_f32_32x32x16_bf16 v[212:227], v[56:59], v[172:175], v[212:227]
  ds_read_b64_tr_b16 v[156:157], v15 offset:24576
  ds_read_b64_tr_b16 v[158:159], v15 offset:26624
  buffer_load_dwordx4 v[108:111], v12, s[4:7], s74 offen sc1
  s_add_u32 s74, s74, s75
  buffer_load_dwordx4 v[112:115], v12, s[4:7], s74 offen sc1
  s_add_u32 s74, s74, s75
  s_waitcnt vmcnt(13) lgkmcnt(4)
  v_mfma_f32_32x32x16_bf16 v[180:195], v[148:151], v[60:63], v[180:195]
  ds_read_b64_tr_b16 v[164:165], v13 offset:28672
  ds_read_b64_tr_b16 v[166:167], v13 offset:30720
  s_waitcnt lgkmcnt(4)
  v_mfma_f32_32x32x16_bf16 v[196:211], v[152:155], v[60:63], v[196:211]
  ds_read_b64_tr_b16 v[168:169], v14 offset:28672
  ds_read_b64_tr_b16 v[170:171], v14 offset:30720
  s_waitcnt lgkmcnt(4)
  v_mfma_f32_32x32x16_bf16 v[212:227], v[60:63], v[156:159], v[212:227]
  ds_read_b64_tr_b16 v[172:173], v15 offset:28672
  ds_read_b64_tr_b16 v[174:175], v15 offset:30720
  buffer_load_dwordx4 v[116:119], v12, s[4:7], s74 offen sc1
  s_add_u32 s74, s74, s75
  buffer_load_dwordx4 v[120:123], v12, s[4:7], s74 offen sc1
  s_add_u32 s74, s74, s75
  s_waitcnt vmcnt(14) lgkmcnt(4)
  v_mfma_f32_32x32x16_bf16 v[180:195], v[164:167], v[64:67], v[180:195]
  ds_read_b64_tr_b16 v[148:149], v13 offset:32768
  ds_read_b64_tr_b16 v[150:151], v13 offset:34816
  s_waitcnt lgkmcnt(4)
  v_mfma_f32_32x32x16_bf16 v[196:211], v[168:171], v[64:67], v[196:211]
  ds_read_b64_tr_b16 v[152:153], v14 offset:32768
  ds_read_b64_tr_b16 v[154:155], v14 offset:34816
  s_waitcnt lgkmcnt(4)
  v_mfma_f32_32x32x16_bf16 v[212:227], v[64:67], v[172:175], v[212:227]
  ds_read_b64_tr_b16 v[156:157], v15 offset:32768
  ds_read_b64_tr_b16 v[158:159], v15 offset:34816
  buffer_load_dwordx4 v[124:127], v12, s[4:7], s74 offen sc1
  s_add_u32 s74, s74, s75
  buffer_load_dwordx4 v[128:131], v12, s[4:7], s74 offen sc1
  s_add_u32 s74, s74, s75
  s_waitcnt vmcnt(15) lgkmcnt(4)
  v_mfma_f32_32x32x16_bf16 v[180:195], v[148:151], v[68:71], v[180:195]
  ds_read_b64_tr_b16 v[164:165], v13 offset:36864
  ds_read_b64_tr_b16 v[166:167], v13 offset:38912
  s_waitcnt lgkmcnt(4)
  v_mfma_f32_32x32x16_bf16 v[196:211], v[152:155], v[68:71], v[196:211]
  ds_read_b64_tr_b16 v[168:169], v14 offset:36864
  ds_read_b64_tr_b16 v[170:171], v14 offset:38912
  s_waitcnt lgkmcnt(4)
  v_mfma_f32_32x32x16_bf16 v[212:227], v[68:71], v[156:159], v[212:227]
  ds_read_b64_tr_b16 v[172:173], v15 offset:36864
  ds_read_b64_tr_b16 v[174:175], v15 offset:38912
  buffer_load_dwordx4 v[132:135], v12, s[4:7], s74 offen sc1
  s_add_u32 s74, s74, s75
  buffer_load_dwordx4 v[136:139], v12, s[4:7], s74 offen sc1
  s_add_u32 s74, s74, s75
  s_waitcnt vmcnt(16) lgkmcnt(4)
  v_mfma_f32_32x32x16_bf16 v[180:195], v[164:167], v[72:75], v[180:195]
  ds_read_b64_tr_b16 v[148:149], v13 offset:40960
  ds_read_b64_tr_b16 v[150:151], v13 offset:43008
  s_waitcnt lgkmcnt(4)
  v_mfma_f32_32x32x16_bf16 v[196:211], v[168:171], v[72:75], v[196:211]
  ds_read_b64_tr_b16 v[152:153], v14 offset:40960
  ds_read_b64_tr_b16 v[154:155], v14 offset:43008
  s_waitcnt lgkmcnt(4)
  v_mfma_f32_32x32x16_bf16 v[212:227], v[72:75], v[172:175], v[212:227]
  ds_read_b64_tr_b16 v[156:157], v15 offset:40960
  ds_read_b64_tr_b16 v[158:159], v15 offset:43008
  buffer_load_dwordx4 v[140:143], v12, s[4:7], s74 offen sc1
  s_add_u32 s74, s74, s75
  s_waitcnt vmcnt(16) lgkmcnt(4)
  v_mfma_f32_32x32x16_bf16 v[180:195], v[148:151], v[76:79], v[180:195]
  ds_read_b64_tr_b16 v[164:165], v13 offset:45056
  ds_read_b64_tr_b16 v[166:167], v13 offset:47104
  s_waitcnt lgkmcnt(4)
  v_mfma_f32_32x32x16_bf16 v[196:211], v[152:155], v[76:79], v[196:211]
  ds_read_b64_tr_b16 v[168:169], v14 offset:45056
  ds_read_b64_tr_b16 v[170:171], v14 offset:47104
  s_waitcnt lgkmcnt(4)
  v_mfma_f32_32x32x16_bf16 v[212:227], v[76:79], v[156:159], v[212:227]
  ds_read_b64_tr_b16 v[172:173], v15 offset:45056
  ds_read_b64_tr_b16 v[174:175], v15 offset:47104
  buffer_load_dwordx4 v[144:147], v12, s[4:7], s74 offen sc1
  s_add_u32 s74, s74, s75
  s_waitcnt vmcnt(16) lgkmcnt(4)
  v_mfma_f32_32x32x16_bf16 v[180:195], v[164:167], v[80:83], v[180:195]
  ds_read_b64_tr_b16 v[148:149], v13 offset:49152
  ds_read_b64_tr_b16 v[150:151], v13 offset:51200
  s_waitcnt lgkmcnt(4)
  v_mfma_f32_32x32x16_bf16 v[196:211], v[168:171], v[80:83], v[196:211]
  ds_read_b64_tr_b16 v[152:153], v14 offset:49152
  ds_read_b64_tr_b16 v[154:155], v14 offset:51200
  s_waitcnt lgkmcnt(4)
  v_mfma_f32_32x32x16_bf16 v[212:227], v[80:83], v[172:175], v[212:227]
  ds_read_b64_tr_b16 v[156:157], v15 offset:49152
  ds_read_b64_tr_b16 v[158:159], v15 offset:51200
  s_waitcnt vmcnt(15) lgkmcnt(4)
  v_mfma_f32_32x32x16_bf16 v[180:195], v[148:151], v[84:87], v[180:195]
  ds_read_b64_tr_b16 v[164:165], v13 offset:53248
  ds_read_b64_tr_b16 v[166:167], v13 offset:55296
  s_waitcnt lgkmcnt(4)
  v_mfma_f32_32x32x16_bf16 v[196:211], v[152:155], v[84:87], v[196:211]
  ds_read_b64_tr_b16 v[168:169], v14 offset:53248
  ds_read_b64_tr_b16 v[170:171], v14 offset:55296
  s_waitcnt lgkmcnt(4)
  v_mfma_f32_32x32x16_bf16 v[212:227], v[84:87], v[156:159], v[212:227]
  ds_read_b64_tr_b16 v[172:173], v15 offset:53248
  ds_read_b64_tr_b16 v[174:175], v15 offset:55296
  s_waitcnt vmcnt(14) lgkmcnt(4)
  v_mfma_f32_32x32x16_bf16 v[180:195], v[164:167], v[88:91], v[180:195]
  ds_read_b64_tr_b16 v[148:149], v13 offset:57344
  ds_read_b64_tr_b16 v[150:151], v13 offset:59392
  s_waitcnt lgkmcnt(4)
  v_mfma_f32_32x32x16_bf16 v[196:211], v[168:171], v[88:91], v[196:211]
  ds_read_b64_tr_b16 v[152:153], v14 offset:57344
  ds_read_b64_tr_b16 v[154:155], v14 offset:59392
  s_waitcnt lgkmcnt(4)
  v_mfma_f32_32x32x16_bf16 v[212:227], v[88:91], v[172:175], v[212:227]
  ds_read_b64_tr_b16 v[156:157], v15 offset:57344
  ds_read_b64_tr_b16 v[158:159], v15 offset:59392
  s_waitcnt vmcnt(13) lgkmcnt(4)
  v_mfma_f32_32x32x16_bf16 v[180:195], v[148:151], v[92:95], v[180:195]
  ds_read_b64_tr_b16 v[164:165], v13 offset:61440
  ds_read_b64_tr_b16 v[166:167], v13 offset:63488
  s_waitcnt lgkmcnt(4)
  v_mfma_f32_32x32x16_bf16 v[196:211], v[152:155], v[92:95], v[196:211]
  ds_read_b64_tr_b16 v[168:169], v14 offset:61440
  ds_read_b64_tr_b16 v[170:171], v14 offset:63488
  s_waitcnt lgkmcnt(4)
  v_mfma_f32_32x32x16_bf16 v[212:227], v[92:95], v[156:159], v[212:227]
  ds_read_b64_tr_b16 v[172:173], v15 offset:61440
  ds_read_b64_tr_b16 v[174:175], v15 offset:63488
  s_waitcnt vmcnt(12) lgkmcnt(4)
  v_mfma_f32_32x32x16_bf16 v[180:195], v[164:167], v[96:99], v[180:195]
  v_add_u32 v13, 0x10000, v13
  ds_read_b64_tr_b16 v[148:149], v13 offset:0
  ds_read_b64_tr_b16 v[150:151], v13 offset:2048
  s_waitcnt lgkmcnt(4)
  v_mfma_f32_32x32x16_bf16 v[196:211], v[168:171], v[96:99], v[196:211]
  v_add_u32 v14, 0x10000, v14
  ds_read_b64_tr_b16 v[152:153], v14 offset:0
  ds_read_b64_tr_b16 v[154:155], v14 offset:2048
  s_waitcnt lgkmcnt(4)
  v_mfma_f32_32x32x16_bf16 v[212:227], v[96:99], v[172:175], v[212:227]
  v_add_u32 v15, 0x10000, v15
  ds_read_b64_tr_b16 v[156:157], v15 offset:0
  ds_read_b64_tr_b16 v[158:159], v15 offset:2048
  s_waitcnt vmcnt(11) lgkmcnt(4)
  v_mfma_f32_32x32x16_bf16 v[180:195], v[148:151], v[100:103], v[180:195]
  ds_read_b64_tr_b16 v[164:165], v13 offset:4096
  ds_read_b64_tr_b16 v[166:167], v13 offset:6144
  s_waitcnt lgkmcnt(4)
  v_mfma_f32_32x32x16_bf16 v[196:211], v[152:155], v[100:103], v[196:211]
  ds_read_b64_tr_b16 v[168:169], v14 offset:4096
  ds_read_b64_tr_b16 v[170:171], v14 offset:6144
  s_waitcnt lgkmcnt(4)
  v_mfma_f32_32x32x16_bf16 v[212:227], v[100:103], v[156:159], v[212:227]
  ds_read_b64_tr_b16 v[172:173], v15 offset:4096
  ds_read_b64_tr_b16 v[174:175], v15 offset:6144
  v_lshlrev_b32 v5, 8, v2
  v_lshl_add_u32 v5, v4, 3, v5
  buffer_load_dwordx2 v[22:23], v5, s[8:11], 0 offen offset:0 sc1
  buffer_load_dwordx2 v[24:25], v5, s[8:11], 0 offen offset:512 sc1
  buffer_load_dwordx2 v[26:27], v5, s[8:11], 0 offen offset:1024 sc1
  buffer_load_dwordx2 v[28:29], v5, s[8:11], 0 offen offset:1536 sc1
  buffer_load_dwordx2 v[30:31], v5, s[8:11], 0 offen offset:2048 sc1
  buffer_load_dwordx2 v[32:33], v5, s[8:11], 0 offen offset:2560 sc1
  buffer_load_dwordx2 v[34:35], v5, s[8:11], 0 offen offset:3072 sc1
  s_waitcnt vmcnt(17) lgkmcnt(4)
  v_mfma_f32_32x32x16_bf16 v[180:195], v[164:167], v[104:107], v[180:195]
  ds_read_b64_tr_b16 v[148:149], v13 offset:8192
  ds_read_b64_tr_b16 v[150:151], v13 offset:10240
  s_waitcnt lgkmcnt(4)
  v_mfma_f32_32x32x16_bf16 v[196:211], v[168:171], v[104:107], v[196:211]
  ds_read_b64_tr_b16 v[152:153], v14 offset:8192
  ds_read_b64_tr_b16 v[154:155], v14 offset:10240
  s_waitcnt lgkmcnt(4)
  v_mfma_f32_32x32x16_bf16 v[212:227], v[104:107], v[172:175], v[212:227]
  ds_read_b64_tr_b16 v[156:157], v15 offset:8192
  ds_read_b64_tr_b16 v[158:159], v15 offset:10240
  s_waitcnt vmcnt(16) lgkmcnt(4)
  v_mfma_f32_32x32x16_bf16 v[180:195], v[148:151], v[108:111], v[180:195]
  ds_read_b64_tr_b16 v[164:165], v13 offset:12288
  ds_read_b64_tr_b16 v[166:167], v13 offset:14336
  s_waitcnt lgkmcnt(4)
  v_mfma_f32_32x32x16_bf16 v[196:211], v[152:155], v[108:111], v[196:211]
  ds_read_b64_tr_b16 v[168:169], v14 offset:12288
  ds_read_b64_tr_b16 v[170:171], v14 offset:14336
  s_waitcnt lgkmcnt(4)
  v_mfma_f32_32x32x16_bf16 v[212:227], v[108:111], v[156:159], v[212:227]
  ds_read_b64_tr_b16 v[172:173], v15 offset:12288
  ds_read_b64_tr_b16 v[174:175], v15 offset:14336
  s_waitcnt vmcnt(15) lgkmcnt(4)
  v_mfma_f32_32x32x16_bf16 v[180:195], v[164:167], v[112:115], v[180:195]
  ds_read_b64_tr_b16 v[148:149], v13 offset:16384
  ds_read_b64_tr_b16 v[150:151], v13 offset:18432
  s_waitcnt lgkmcnt(4)
  v_mfma_f32_32x32x16_bf16 v[196:211], v[168:171], v[112:115], v[196:211]
  ds_read_b64_tr_b16 v[152:153], v14 offset:16384
  ds_read_b64_tr_b16 v[154:155], v14 offset:18432
  s_waitcnt lgkmcnt(4)
  v_mfma_f32_32x32x16_bf16 v[212:227], v[112:115], v[172:175], v[212:227]
  ds_read_b64_tr_b16 v[156:157], v15 offset:16384
  ds_read_b64_tr_b16 v[158:159], v15 offset:18432
  s_waitcnt vmcnt(14) lgkmcnt(4)
  v_mfma_f32_32x32x16_bf16 v[180:195], v[148:151], v[116:119], v[180:195]
  ds_read_b64_tr_b16 v[164:165], v13 offset:20480
  ds_read_b64_tr_b16 v[166:167], v13 offset:22528
  s_waitcnt lgkmcnt(4)
  v_mfma_f32_32x32x16_bf16 v[196:211], v[152:155], v[116:119], v[196:211]
  ds_read_b64_tr_b16 v[168:169], v14 offset:20480
  ds_read_b64_tr_b16 v[170:171], v14 offset:22528
  s_waitcnt lgkmcnt(4)
  v_mfma_f32_32x32x16_bf16 v[212:227], v[116:119], v[156:159], v[212:227]
  ds_read_b64_tr_b16 v[172:173], v15 offset:20480
  ds_read_b64_tr_b16 v[174:175], v15 offset:22528
  s_waitcnt vmcnt(13) lgkmcnt(4)
  v_mfma_f32_32x32x16_bf16 v[180:195], v[164:167], v[120:123], v[180:195]
  ds_read_b64_tr_b16 v[148:149], v13 offset:24576
  ds_read_b64_tr_b16 v[150:151], v13 offset:26624
  s_waitcnt lgkmcnt(4)
  v_mfma_f32_32x32x16_bf16 v[196:211], v[168:171], v[120:123], v[196:211]
  ds_read_b64_tr_b16 v[152:153], v14 offset:24576
  ds_read_b64_tr_b16 v[154:155], v14 offset:26624
  s_waitcnt lgkmcnt(4)
  v_mfma_f32_32x32x16_bf16 v[212:227], v[120:123], v[172:175], v[212:227]
  ds_read_b64_tr_b16 v[156:157], v15 offset:24576
  ds_read_b64_tr_b16 v[158:159], v15 offset:26624
  s_waitcnt vmcnt(12) lgkmcnt(4)
  v_mfma_f32_32x32x16_bf16 v[180:195], v[148:151], v[124:127], v[180:195]
  ds_read_b64_tr_b16 v[164:165], v13 offset:28672
  ds_read_b64_tr_b16 v[166:167], v13 offset:30720
  s_waitcnt lgkmcnt(4)
  v_mfma_f32_32x32x16_bf16 v[196:211], v[152:155], v[124:127], v[196:211]
  ds_read_b64_tr_b16 v[168:169], v14 offset:28672
  ds_read_b64_tr_b16 v[170:171], v14 offset:30720
  s_waitcnt lgkmcnt(4)
  v_mfma_f32_32x32x16_bf16 v[212:227], v[124:127], v[156:159], v[212:227]
  ds_read_b64_tr_b16 v[172:173], v15 offset:28672
  ds_read_b64_tr_b16 v[174:175], v15 offset:30720
  s_waitcnt vmcnt(11) lgkmcnt(4)
  v_mfma_f32_32x32x16_bf16 v[180:195], v[164:167], v[128:131], v[180:195]
  ds_read_b64_tr_b16 v[148:149], v13 offset:32768
  ds_read_b64_tr_b16 v[150:151], v13 offset:34816
  s_waitcnt lgkmcnt(4)
  v_mfma_f32_32x32x16_bf16 v[196:211], v[168:171], v[128:131], v[196:211]
  ds_read_b64_tr_b16 v[152:153], v14 offset:32768
  ds_read_b64_tr_b16 v[154:155], v14 offset:34816
  s_waitcnt lgkmcnt(4)
  v_mfma_f32_32x32x16_bf16 v[212:227], v[128:131], v[172:175], v[212:227]
  ds_read_b64_tr_b16 v[156:157], v15 offset:32768
  ds_read_b64_tr_b16 v[158:159], v15 offset:34816
  s_waitcnt vmcnt(10) lgkmcnt(4)
  v_mfma_f32_32x32x16_bf16 v[180:195], v[148:151], v[132:135], v[180:195]
  ds_read_b64_tr_b16 v[164:165], v13 offset:36864
  ds_read_b64_tr_b16 v[166:167], v13 offset:38912
  s_waitcnt lgkmcnt(4)
  v_mfma_f32_32x32x16_bf16 v[196:211], v[152:155], v[132:135], v[196:211]
  ds_read_b64_tr_b16 v[168:169], v14 offset:36864
  ds_read_b64_tr_b16 v[170:171], v14 offset:38912
  s_waitcnt lgkmcnt(4)
  v_mfma_f32_32x32x16_bf16 v[212:227], v[132:135], v[156:159], v[212:227]
  ds_read_b64_tr_b16 v[172:173], v15 offset:36864
  ds_read_b64_tr_b16 v[174:175], v15 offset:38912
  s_waitcnt vmcnt(9) lgkmcnt(4)
  v_mfma_f32_32x32x16_bf16 v[180:195], v[164:167], v[136:139], v[180:195]
  ds_read_b64_tr_b16 v[148:149], v13 offset:40960
  ds_read_b64_tr_b16 v[150:151], v13 offset:43008
  s_waitcnt lgkmcnt(4)
  v_mfma_f32_32x32x16_bf16 v[196:211], v[168:171], v[136:139], v[196:211]
  ds_read_b64_tr_b16 v[152:153], v14 offset:40960
  ds_read_b64_tr_b16 v[154:155], v14 offset:43008
  s_waitcnt lgkmcnt(4)
  v_mfma_f32_32x32x16_bf16 v[212:227], v[136:139], v[172:175], v[212:227]
  ds_read_b64_tr_b16 v[156:157], v15 offset:40960
  ds_read_b64_tr_b16 v[158:159], v15 offset:43008
  s_waitcnt vmcnt(8) lgkmcnt(4)
  v_mfma_f32_32x32x16_bf16 v[180:195], v[148:151], v[140:143], v[180:195]
  ds_read_b64_tr_b16 v[164:165], v13 offset:45056
  ds_read_b64_tr_b16 v[166:167], v13 offset:47104
  s_waitcnt lgkmcnt(4)
  v_mfma_f32_32x32x16_bf16 v[196:211], v[152:155], v[140:143], v[196:211]
  ds_read_b64_tr_b16 v[168:169], v14 offset:45056
  ds_read_b64_tr_b16 v[170:171], v14 offset:47104
  s_waitcnt lgkmcnt(4)
  v_mfma_f32_32x32x16_bf16 v[212:227], v[140:143], v[156:159], v[212:227]
  ds_read_b64_tr_b16 v[172:173], v15 offset:45056
  ds_read_b64_tr_b16 v[174:175], v15 offset:47104
  s_waitcnt vmcnt(7) lgkmcnt(4)
  v_mfma_f32_32x32x16_bf16 v[180:195], v[164:167], v[144:147], v[180:195]
  s_waitcnt lgkmcnt(2)
  v_mfma_f32_32x32x16_bf16 v[196:211], v[168:171], v[144:147], v[196:211]
  s_waitcnt lgkmcnt(0)
  v_mfma_f32_32x32x16_bf16 v[212:227], v[144:147], v[172:175], v[212:227]
  s_waitcnt vmcnt(0)
  s_cmp_eq_u32 s3, 0
  s_nop 4
  s_cbranch_scc0 L_qkv_hasc
  s_barrier
  v_lshlrev_b32 v6, 2, v4
  v_add_u32 v6, 162816, v6
  ds_read_b32 v19, v6 offset:0
  ds_read_b32 v20, v6 offset:128
  ds_read_b32 v21, v6 offset:256
L_qkv_hasc:
  v_pk_add_f32 v[24:25], v[24:25], v[26:27]
  v_pk_add_f32 v[28:29], v[28:29], v[30:31]
  v_pk_add_f32 v[32:33], v[32:33], v[34:35]
  v_pk_add_f32 v[22:23], v[22:23], v[24:25]
  v_pk_add_f32 v[28:29], v[28:29], v[32:33]
  v_pk_add_f32 v[22:23], v[22:23], v[28:29]
  v_mov_b32 v5, v22
  s_nop 1
  v_permlane32_swap_b32 v22, v5
  v_add_f32 v22, v22, v5
  v_mov_b32 v6, v23
  s_nop 1
  v_permlane32_swap_b32 v23, v6
  v_add_f32 v23, v23, v6
  v_mul_f32 v17, 0x3b124925, v22
  v_mul_f32 v5, 0x3b124925, v23
  v_fma_f32 v5, -v17, v17, v5
  v_max_f32 v5, 0, v5
  v_add_f32 v5, 0x3727c5ac, v5
  v_rsq_f32 v16, v5
  s_nop 0
  v_mul_f32 v18, v5, v16
  v_sub_f32 v7, 0, v17
  v_cvt_pk_bf16_f32 v8, v7, v7
  v_and_b32 v8, 0xffff0000, v8
  v_sub_f32 v8, v7, v8
  v_cvt_pk_bf16_f32 v228, v7, v8
  v_mov_b32 v229, v228
  v_cvt_pk_bf16_f32 v8, v18, v18
  v_and_b32 v8, 0xffff0000, v8
  v_sub_f32 v8, v18, v8
  v_cvt_pk_bf16_f32 v230, v18, v8
  v_mov_b32 v231, 0
  v_mov_b32 v8, 0
  v_cndmask_b32 v228, v228, v8, s[50:51]
  v_cndmask_b32 v229, v229, v8, s[50:51]
  v_cndmask_b32 v230, v230, v8, s[50:51]
  s_waitcnt lgkmcnt(0)
  v_cvt_pk_bf16_f32 v148, v19, v19
  v_and_b32 v8, 0xffff0000, v148
  v_sub_f32 v8, v19, v8
  v_cvt_pk_bf16_f32 v149, v8, v8
  v_mov_b32 v150, 0
  v_mov_b32 v151, 0
  v_cvt_pk_bf16_f32 v152, v20, v20
  v_and_b32 v8, 0xffff0000, v152
  v_sub_f32 v8, v20, v8
  v_cvt_pk_bf16_f32 v153, v8, v8
  v_mov_b32 v154, 0
  v_mov_b32 v155, 0
  v_cvt_pk_bf16_f32 v156, v21, v21
  v_and_b32 v8, 0xffff0000, v156
  v_sub_f32 v8, v21, v8
  v_cvt_pk_bf16_f32 v157, v8, v8
  v_mov_b32 v158, 0
  v_mov_b32 v159, 0
  v_mfma_f32_32x32x16_bf16 v[180:195], v[148:151], v[228:231], v[180:195]
  v_mfma_f32_32x32x16_bf16 v[196:211], v[152:155], v[228:231], v[196:211]
  v_mfma_f32_32x32x16_bf16 v[212:227], v[228:231], v[156:159], v[212:227]
  s_add_u32 s12, s48, s72
  s_addc_u32 s13, s49, 0
  s_and_b32 s13, s13, 0xffff
  s_mov_b32 s14, 6291456
  s_mov_b32 s15, 0x20000
  s_lshl_b32 s26, s20, 7
  s_add_u32 s26, s26, 163328
  v_lshl_add_u32 v6, v4, 2, s26
  ds_write_b32 v6, v16
  v_lshl_add_u32 v6, v2, 4, s26
  s_waitcnt lgkmcnt(0)
  ds_read_b128 v[164:167], v6 offset:0
  ds_read_b128 v[168:171], v6 offset:32
  ds_read_b128 v[172:175], v6 offset:64
  ds_read_b128 v[176:179], v6 offset:96
  s_lshl_b32 s27, s61, 6
  s_add_u32 s27, s27, s62
  s_lshl_b32 s27, s27, 11
  v_mul_f32 v7, 0x3e8b97f6, v16
  v_mul_f32 v180, v180, v7
  v_mul_f32 v181, v181, v7
  v_mul_f32 v182, v182, v7
  v_mul_f32 v183, v183, v7
  v_mul_f32 v184, v184, v7
  v_mul_f32 v185, v185, v7
  v_mul_f32 v186, v186, v7
  v_mul_f32 v187, v187, v7
  v_mul_f32 v188, v188, v7
  v_mul_f32 v189, v189, v7
  v_mul_f32 v190, v190, v7
  v_mul_f32 v191, v191, v7
  v_mul_f32 v192, v192, v7
  v_mul_f32 v193, v193, v7
  v_mul_f32 v194, v194, v7
  v_mul_f32 v195, v195, v7
  v_mul_f32 v196, v196, v16
  v_mul_f32 v197, v197, v16
  v_mul_f32 v198, v198, v16
  v_mul_f32 v199, v199, v16
  v_mul_f32 v200, v200, v16
  v_mul_f32 v201, v201, v16
  v_mul_f32 v202, v202, v16
  v_mul_f32 v203, v203, v16
  v_mul_f32 v204, v204, v16
  v_mul_f32 v205, v205, v16
  v_mul_f32 v206, v206, v16
  v_mul_f32 v207, v207, v16
  v_mul_f32 v208, v208, v16
  v_mul_f32 v209, v209, v16
  v_mul_f32 v210, v210, v16
  v_mul_f32 v211, v211, v16
  v_mul_f32 v5, v180, v196
  v_fmac_f32 v5, v181, v197
  v_fmac_f32 v5, v182, v198
  v_fmac_f32 v5, v183, v199
  v_fmac_f32 v5, v184, v200
  v_fmac_f32 v5, v185, v201
  v_fmac_f32 v5, v186, v202
  v_fmac_f32 v5, v187, v203
  v_fmac_f32 v5, v188, v204
  v_fmac_f32 v5, v189, v205
  v_fmac_f32 v5, v190, v206
  v_fmac_f32 v5, v191, v207
  v_mul_f32 v6, v192, v208
  v_fmac_f32 v6, v193, v209
  v_fmac_f32 v6, v194, v210
  v_fmac_f32 v6, v195, v211
  v_mov_b32 v8, 0
  v_cndmask_b32 v6, v6, v8, s[50:51]
  v_add_f32 v5, v5, v6
  v_mov_b32 v6, v5
  s_nop 1
  v_permlane32_swap_b32 v5, v6
  v_add_f32 v5, v5, v6
  v_sub_f32 v5, 0, v5
  v_cvt_pk_bf16_f32 v228, v180, v181
  v_cvt_pk_bf16_f32 v229, v182, v183
  v_cvt_pk_bf16_f32 v230, v184, v185
  v_cvt_pk_bf16_f32 v231, v186, v187
  v_cvt_pk_bf16_f32 v232, v188, v189
  v_cvt_pk_bf16_f32 v233, v190, v191
  v_cvt_pk_bf16_f32 v234, v192, v193
  v_cvt_pk_bf16_f32 v235, v194, v195
  v_cvt_pk_bf16_f32 v5, v5, v8
  v_cndmask_b32 v234, v234, v5, s[50:51]
  v_cndmask_b32 v235, v235, v8, s[50:51]
  buffer_store_dwordx4 v[228:231], v3, s[12:15], s27 offen sc1
  buffer_store_dwordx4 v[232:235], v3, s[12:15], s27 offen offset:1024 sc1
  v_cvt_pk_bf16_f32 v236, v196, v197
  v_cvt_pk_bf16_f32 v237, v198, v199
  v_cvt_pk_bf16_f32 v238, v200, v201
  v_cvt_pk_bf16_f32 v239, v202, v203
  v_cvt_pk_bf16_f32 v240, v204, v205
  v_cvt_pk_bf16_f32 v241, v206, v207
  v_cvt_pk_bf16_f32 v242, v208, v209
  v_cvt_pk_bf16_f32 v243, v210, v211
  v_mov_b32 v5, 0x3f803f80
  v_mov_b32 v6, 0x3f80
  v_cndmask_b32 v242, v242, v5, s[50:51]
  v_cndmask_b32 v243, v243, v6, s[50:51]
  s_add_u32 s26, s27, 2097152
  buffer_store_dwordx4 v[236:239], v3, s[12:15], s26 offen sc1
  buffer_store_dwordx4 v[240:243], v3, s[12:15], s26 offen offset:1024 sc1
  s_waitcnt lgkmcnt(0)
  v_mul_f32 v212, v212, v164
  v_mul_f32 v213, v213, v165
  v_mul_f32 v214, v214, v166
  v_mul_f32 v215, v215, v167
  v_mul_f32 v216, v216, v168
  v_mul_f32 v217, v217, v169
  v_mul_f32 v218, v218, v170
  v_mul_f32 v219, v219, v171
  v_mul_f32 v220, v220, v172
  v_mul_f32 v221, v221, v173
  v_mul_f32 v222, v222, v174
  v_mul_f32 v223, v223, v175
  v_mul_f32 v224, v224, v176
  v_mul_f32 v225, v225, v177
  v_mul_f32 v226, v226, v178
  v_mul_f32 v227, v227, v179
  v_cmp_le_u32 s[70:71], 28, v4
  v_cmp_eq_u32 vcc, 28, v4
  v_mov_b32 v6, 0x3f803f80
  s_nop 0
  v_cndmask_b32 v6, v8, v6, vcc
  v_cvt_pk_bf16_f32 v148, v212, v213
  v_cvt_pk_bf16_f32 v149, v214, v215
  v_cvt_pk_bf16_f32 v150, v216, v217
  v_cvt_pk_bf16_f32 v151, v218, v219
  v_cvt_pk_bf16_f32 v152, v220, v221
  v_cvt_pk_bf16_f32 v153, v222, v223
  v_cvt_pk_bf16_f32 v154, v224, v225
  v_cvt_pk_bf16_f32 v155, v226, v227
  v_cndmask_b32 v148, v148, v6, s[70:71]
  v_cndmask_b32 v149, v149, v6, s[70:71]
  v_cndmask_b32 v150, v150, v6, s[70:71]
  v_cndmask_b32 v151, v151, v6, s[70:71]
  v_cndmask_b32 v152, v152, v6, s[70:71]
  v_cndmask_b32 v153, v153, v6, s[70:71]
  v_cndmask_b32 v154, v154, v6, s[70:71]
  v_cndmask_b32 v155, v155, v6, s[70:71]
  s_add_u32 s26, s27, 4194304
  buffer_store_dwordx4 v[148:151], v3, s[12:15], s26 offen sc1
  buffer_store_dwordx4 v[152:155], v3, s[12:15], s26 offen offset:1024 sc1
  s_waitcnt vmcnt(0)
  s_barrier
  s_cmp_eq_u32 s20, 0
  s_nop 0
  s_cbranch_scc0 L_sig_13
  s_mul_i32 s25, s3, 80
  s_add_u32 s25, s25, 0
  s_add_u32 s25, s25, s61
  s_lshl_b32 s25, s25, 8
  v_mov_b32 v5, s25
  v_mov_b32 v6, 1
  s_mov_b64 exec, 1
  buffer_atomic_add v6, v5, s[52:55], 0 offen sc1
  s_mov_b64 exec, -1
L_sig_13:
  s_cmp_eq_u32 s3, 0
  s_cbranch_scc0 L_nsw_14
  s_cmp_eq_u32 s20, 0
  s_nop 0
  s_cbranch_scc0 L_nsw_14w
  v_mov_b32 v5, 163836
  s_mov_b64 exec, 1
  ds_write_b32 v5, v11
  s_mov_b64 exec, -1
  s_waitcnt lgkmcnt(0)
L_nsw_14w:
  s_barrier
  v_mov_b32 v5, 163836
  ds_read_b32 v6, v5
  s_waitcnt lgkmcnt(0)
  v_readfirstlane_b32 s22, v6
  s_nop 0
  s_and_b32 s22, s22, 31
  s_mov_b32 s21, s90
  s_lshr_b32 s23, s21, 1
  s_and_b32 s24, s21, 1
L_nsw_14:
  s_lshl_b32 s64, s21, 2
  s_and_b32 s25, s22, 3
  s_add_u32 s64, s64, s25
  s_lshr_b32 s61, s22, 2
  s_lshr_b32 s60, s64, 1
  s_lshl_b32 s62, s64, 1
  s_lshr_b32 s25, s20, 1
  s_add_u32 s62, s62, s25
  s_lshl_b32 s63, s61, 1
  s_and_b32 s25, s20, 1
  s_add_u32 s63, s63, s25
  s_cmp_eq_u32 s3, 0
  s_cbranch_scc0 L_nowo_stage
  s_cmp_lt_u32 s61, 7
  s_cbranch_scc0 L_nowo_stage
  v_lshrrev_b32 v5, 3, v1
  v_and_b32 v6, 7, v1
  v_bfe_u32 v7, v1, 4, 1
  v_lshlrev_b32 v7, 2, v7
  v_xor_b32 v6, v6, v7
  v_mul_u32_u24 v228, 896, v5
  v_lshlrev_b32 v6, 4, v6
  v_add_u32 v228, v228, v6
  s_lshl_b32 s25, s61, 7
  v_add_u32 v228, s25, v228
  s_add_u32 s76, s32, 0
  s_addc_u32 s77, s33, 0
  s_and_b32 s77, s77, 0xffff
  s_mov_b32 s78, 401408
  s_mov_b32 s79, 0x20000
  s_mul_i32 s57, s20, 28672
  v_bfe_u32 v5, v1, 2, 2
  v_lshlrev_b32 v6, 2, v2
  v_add_u32 v6, v6, v5
  v_lshlrev_b32 v6, 7, v6
  v_and_b32 v7, 3, v1
  v_lshlrev_b32 v7, 3, v7
  v_add_u32 v6, v6, v7
  v_bfe_u32 v7, v1, 4, 1
  v_lshlrev_b32 v7, 5, v7
  v_add_u32 v6, v6, v7
  v_bfe_u32 v7, v1, 3, 1
  s_and_b32 s25, s20, 1
  v_xor_b32 v7, s25, v7
  v_lshlrev_b32 v7, 6, v7
  v_add_u32 v6, s57, v6
  v_add_u32 v229, v6, v7
  v_xor_b32 v7, 64, v7
  v_add_u32 v230, v6, v7
  s_mul_i32 s58, s20, 100352
  s_add_u32 m0, s57, 0
  s_add_u32 s25, s58, 0
  buffer_load_dwordx4 v228, s[76:79], s25 offen lds
  s_add_u32 m0, s57, 1024
  s_add_u32 s25, s58, 7168
  buffer_load_dwordx4 v228, s[76:79], s25 offen lds
  s_add_u32 m0, s57, 2048
  s_add_u32 s25, s58, 14336
  buffer_load_dwordx4 v228, s[76:79], s25 offen lds
  s_add_u32 m0, s57, 3072
  s_add_u32 s25, s58, 21504
  buffer_load_dwordx4 v228, s[76:79], s25 offen lds
  s_add_u32 m0, s57, 4096
  s_add_u32 s25, s58, 25088
  buffer_load_dwordx4 v228, s[76:79], s25 offen lds
  s_add_u32 m0, s57, 5120
  s_add_u32 s25, s58, 32256
  buffer_load_dwordx4 v228, s[76:79], s25 offen lds
  s_add_u32 m0, s57, 6144
  s_add_u32 s25, s58, 39424
  buffer_load_dwordx4 v228, s[76:79], s25 offen lds
  s_add_u32 m0, s57, 7168
  s_add_u32 s25, s58, 46592
  buffer_load_dwordx4 v228, s[76:79], s25 offen lds
  s_add_u32 m0, s57, 8192
  s_add_u32 s25, s58, 50176
  buffer_load_dwordx4 v228, s[76:79], s25 offen lds
  s_add_u32 m0, s57, 9216
  s_add_u32 s25, s58, 57344
  buffer_load_dwordx4 v228, s[76:79], s25 offen lds
  s_add_u32 m0, s57, 10240
  s_add_u32 s25, s58, 64512
  buffer_load_dwordx4 v228, s[76:79], s25 offen lds
  s_add_u32 m0, s57, 11264
  s_add_u32 s25, s58, 71680
  buffer_load_dwordx4 v228, s[76:79], s25 offen lds
  s_add_u32 m0, s57, 12288
  s_add_u32 s25, s58, 75264
  buffer_load_dwordx4 v228, s[76:79], s25 offen lds
  s_add_u32 m0, s57, 13312
  s_add_u32 s25, s58, 82432
  buffer_load_dwordx4 v228, s[76:79], s25 offen lds
  s_add_u32 m0, s57, 14336
  s_add_u32 s25, s58, 89600
  buffer_load_dwordx4 v228, s[76:79], s25 offen lds
  s_add_u32 m0, s57, 15360
  s_add_u32 s25, s58, 96768
  buffer_load_dwordx4 v228, s[76:79], s25 offen lds
  s_add_u32 s74, s57, 16384
  s_add_u32 s84, s40, 0
  s_addc_u32 s85, s41, 0
  s_and_b32 s85, s85, 0xffff
  s_mov_b32 s86, 1605632
  s_mov_b32 s87, 0x20000
  s_mul_i32 s26, s20, 401408
  s_add_u32 m0, s74, 0
  s_add_u32 s27, s26, 0
  buffer_load_dwordx4 v228, s[84:87], s27 offen lds
  s_add_u32 m0, s74, 1024
  s_add_u32 s27, s26, 7168
  buffer_load_dwordx4 v228, s[84:87], s27 offen lds
  s_add_u32 m0, s74, 2048
  s_add_u32 s27, s26, 14336
  buffer_load_dwordx4 v228, s[84:87], s27 offen lds
  s_add_u32 m0, s74, 3072
  s_add_u32 s27, s26, 21504
  buffer_load_dwordx4 v228, s[84:87], s27 offen lds
  s_add_u32 m0, s74, 4096
  s_add_u32 s27, s26, 28672
  buffer_load_dwordx4 v228, s[84:87], s27 offen lds
  s_add_u32 m0, s74, 5120
  s_add_u32 s27, s26, 35840
  buffer_load_dwordx4 v228, s[84:87], s27 offen lds
  s_add_u32 m0, s74, 6144
  s_add_u32 s27, s26, 43008
  buffer_load_dwordx4 v228, s[84:87], s27 offen lds
  s_add_u32 m0, s74, 7168
  s_add_u32 s27, s26, 50176
  buffer_load_dwordx4 v228, s[84:87], s27 offen lds
  s_add_u32 m0, s74, 8192
  s_add_u32 s27, s26, 57344
  buffer_load_dwordx4 v228, s[84:87], s27 offen lds
  s_add_u32 m0, s74, 9216
  s_add_u32 s27, s26, 64512
  buffer_load_dwordx4 v228, s[84:87], s27 offen lds
  s_add_u32 m0, s74, 10240
  s_add_u32 s27, s26, 71680
  buffer_load_dwordx4 v228, s[84:87], s27 offen lds
  s_add_u32 m0, s74, 11264
  s_add_u32 s27, s26, 78848
  buffer_load_dwordx4 v228, s[84:87], s27 offen lds
  s_waitcnt vmcnt(24)
  ds_read_b64_tr_b16 a[0:1], v229 offset:0
  ds_read_b64_tr_b16 a[2:3], v229 offset:1024
  ds_read_b64_tr_b16 a[4:5], v230 offset:0
  ds_read_b64_tr_b16 a[6:7], v230 offset:1024
  ds_read_b64_tr_b16 a[8:9], v229 offset:2048
  ds_read_b64_tr_b16 a[10:11], v229 offset:3072
  ds_read_b64_tr_b16 a[12:13], v230 offset:2048
  ds_read_b64_tr_b16 a[14:15], v230 offset:3072
  s_waitcnt vmcnt(20)
  ds_read_b64_tr_b16 a[16:17], v229 offset:4096
  ds_read_b64_tr_b16 a[18:19], v229 offset:5120
  ds_read_b64_tr_b16 a[20:21], v230 offset:4096
  ds_read_b64_tr_b16 a[22:23], v230 offset:5120
  ds_read_b64_tr_b16 a[24:25], v229 offset:6144
  ds_read_b64_tr_b16 a[26:27], v229 offset:7168
  ds_read_b64_tr_b16 a[28:29], v230 offset:6144
  ds_read_b64_tr_b16 a[30:31], v230 offset:7168
  s_waitcnt vmcnt(16)
  ds_read_b64_tr_b16 a[32:33], v229 offset:8192
  ds_read_b64_tr_b16 a[34:35], v229 offset:9216
  ds_read_b64_tr_b16 a[36:37], v230 offset:8192
  ds_read_b64_tr_b16 a[38:39], v230 offset:9216
  ds_read_b64_tr_b16 a[40:41], v229 offset:10240
  ds_read_b64_tr_b16 a[42:43], v229 offset:11264
  ds_read_b64_tr_b16 a[44:45], v230 offset:10240
  ds_read_b64_tr_b16 a[46:47], v230 offset:11264
  s_waitcnt vmcnt(12)
  ds_read_b64_tr_b16 a[48:49], v229 offset:12288
  ds_read_b64_tr_b16 a[50:51], v229 offset:13312
  ds_read_b64_tr_b16 a[52:53], v230 offset:12288
  ds_read_b64_tr_b16 a[54:55], v230 offset:13312
  ds_read_b64_tr_b16 a[56:57], v229 offset:14336
  ds_read_b64_tr_b16 a[58:59], v229 offset:15360
  ds_read_b64_tr_b16 a[60:61], v230 offset:14336
  ds_read_b64_tr_b16 a[62:63], v230 offset:15360
  s_waitcnt vmcnt(10)
  ds_read_b64_tr_b16 a[64:65], v229 offset:16384
  ds_read_b64_tr_b16 a[66:67], v229 offset:17408
  ds_read_b64_tr_b16 a[68:69], v230 offset:16384
  ds_read_b64_tr_b16 a[70:71], v230 offset:17408
  s_waitcnt vmcnt(8)
  ds_read_b64_tr_b16 a[72:73], v229 offset:18432
  ds_read_b64_tr_b16 a[74:75], v229 offset:19456
  ds_read_b64_tr_b16 a[76:77], v230 offset:18432
  ds_read_b64_tr_b16 a[78:79], v230 offset:19456
  s_waitcnt vmcnt(6)
  ds_read_b64_tr_b16 a[80:81], v229 offset:20480
  ds_read_b64_tr_b16 a[82:83], v229 offset:21504
  ds_read_b64_tr_b16 a[84:85], v230 offset:20480
  ds_read_b64_tr_b16 a[86:87], v230 offset:21504
  s_waitcnt vmcnt(4)
  ds_read_b64_tr_b16 a[88:89], v229 offset:22528
  ds_read_b64_tr_b16 a[90:91], v229 offset:23552
  ds_read_b64_tr_b16 a[92:93], v230 offset:22528
  ds_read_b64_tr_b16 a[94:95], v230 offset:23552
  s_waitcnt vmcnt(2)
  ds_read_b64_tr_b16 a[96:97], v229 offset:24576
  ds_read_b64_tr_b16 a[98:99], v229 offset:25600
  ds_read_b64_tr_b16 a[100:101], v230 offset:24576
  ds_read_b64_tr_b16 a[102:103], v230 offset:25600
  s_waitcnt vmcnt(0)
  ds_read_b64_tr_b16 a[104:105], v229 offset:26624
  ds_read_b64_tr_b16 a[106:107], v229 offset:27648
  ds_read_b64_tr_b16 a[108:109], v230 offset:26624
  ds_read_b64_tr_b16 a[110:111], v230 offset:27648
  s_waitcnt lgkmcnt(0)
L_nowo_stage:
  s_and_b32 s68, s22, 1
  s_lshl_b32 s68, s68, 3
  s_add_u32 s68, s68, s21
  s_lshr_b32 s69, s22, 1
  s_lshl_b32 s60, s21, 1
  s_and_b32 s25, s22, 1
  s_add_u32 s60, s60, s25
  s_lshr_b32 s61, s22, 1
  v_lshrrev_b32 v5, 4, v1
  v_and_b32 v6, 15, v1
  v_lshlrev_b32 v7, 2, v5
  v_xor_b32 v6, v6, v7
  s_mov_b32 s25, s20
  s_lshl_b32 s25, s25, 2
  v_add_u32 v5, s25, v5
  v_mul_u32_u24 v9, 3584, v5
  v_lshlrev_b32 v8, 4, v6
  v_add_u32 v9, v9, v8
  s_lshl_b32 s25, s61, 8
  v_add_u32 v9, s25, v9
  s_add_u32 s76, s36, 0
  s_addc_u32 s77, s37, 0
  s_and_b32 s77, s77, 0xffff
  s_mov_b32 s78, 1605632
  s_mov_b32 s79, 0x20000
  s_lshl_b32 s57, s20, 10
  s_mov_b32 s58, 0
  s_cmp_lt_u32 s22, 28
  s_cselect_b32 s78, s78, 0
  s_add_u32 s4, s48, s72
  s_addc_u32 s5, s49, 0
  s_and_b32 s5, s5, 0xffff
  s_mov_b32 s6, 6291456
  s_mov_b32 s7, 0x20000
  s_add_u32 s25, s72, 4194304
  s_add_u32 s8, s48, s25
  s_addc_u32 s9, s49, 0
  s_and_b32 s9, s9, 0xffff
  s_mov_b32 s10, 2097152
  s_mov_b32 s11, 0x20000
  s_add_u32 s25, s72, 6291456
  s_add_u32 s12, s48, s25
  s_addc_u32 s13, s49, 0
  s_and_b32 s13, s13, 0xffff
  s_mov_b32 s14, 2097152
  s_mov_b32 s15, 0x20000
  s_lshl_b32 s65, s68, 6
  s_lshl_b32 s26, s20, 4
  s_add_u32 s65, s65, s26
  s_lshl_b32 s65, s65, 11
  s_mov_b32 s74, s65
  s_add_u32 s65, s65, 2097152
  s_lshl_b32 s66, s68, 6
  s_lshl_b32 s26, s69, 2
  s_add_u32 s66, s66, s26
  s_lshl_b32 s66, s66, 11
  v_mov_b32 v156, 0
  v_mov_b32 v157, 0
  v_mov_b32 v158, 0
  v_mov_b32 v159, 0
  v_mov_b32 v160, 0
  v_mov_b32 v161, 0
  v_mov_b32 v162, 0
  v_mov_b32 v163, 0
  v_mov_b32 v164, 0
  v_mov_b32 v165, 0
  v_mov_b32 v166, 0
  v_mov_b32 v167, 0
  v_mov_b32 v168, 0
  v_mov_b32 v169, 0
  v_mov_b32 v170, 0
  v_mov_b32 v171, 0
  v_mov_b32 v172, 0
  v_mov_b32 v173, 0
  v_mov_b32 v174, 0
  v_mov_b32 v175, 0
  v_mov_b32 v176, 0
  v_mov_b32 v177, 0
  v_mov_b32 v178, 0
  v_mov_b32 v179, 0
  v_mov_b32 v180, 0
  v_mov_b32 v181, 0
  v_mov_b32 v182, 0
  v_mov_b32 v183, 0
  v_mov_b32 v184, 0
  v_mov_b32 v185, 0
  v_mov_b32 v186, 0
  v_mov_b32 v187, 0
  v_mov_b32 v188, 0
  v_mov_b32 v189, 0
  v_mov_b32 v190, 0
  v_mov_b32 v191, 0
  v_mov_b32 v192, 0
  v_mov_b32 v193, 0
  v_mov_b32 v194, 0
  v_mov_b32 v195, 0
  v_mov_b32 v196, 0
  v_mov_b32 v197, 0
  v_mov_b32 v198, 0
  v_mov_b32 v199, 0
  v_mov_b32 v200, 0
  v_mov_b32 v201, 0
  v_mov_b32 v202, 0
  v_mov_b32 v203, 0
  v_mov_b32 v204, 0
  v_mov_b32 v205, 0
  v_mov_b32 v206, 0
  v_mov_b32 v207, 0
  v_mov_b32 v208, 0
  v_mov_b32 v209, 0
  v_mov_b32 v210, 0
  v_mov_b32 v211, 0
  v_mov_b32 v212, 0
  v_mov_b32 v213, 0
  v_mov_b32 v214, 0
  v_mov_b32 v215, 0
  v_mov_b32 v216, 0
  v_mov_b32 v217, 0
  v_mov_b32 v218, 0
  v_mov_b32 v219, 0
  s_cmp_eq_u32 s20, 0
  s_cbranch_scc0 L_wt_15
  s_mul_i32 s25, s3, 80
  s_add_u32 s25, s25, 0
  s_add_u32 s25, s25, s68
  s_lshl_b32 s25, s25, 8
  v_mov_b32 v5, s25
  s_mov_b32 s26, 0
L_sp_16:
  buffer_load_dword v6, v5, s[52:55], 0 offen sc1
  s_waitcnt vmcnt(0)
  v_readfirstlane_b32 s25, v6
  s_add_u32 s26, s26, 1
  s_cmp_gt_u32 s26, 20000
  s_cbranch_scc1 L_wt_15x
  s_cmp_lt_u32 s25, 16
  s_cbranch_scc1 L_sp_16
L_wt_15x:
L_wt_15:
  s_barrier
  s_xor_b32 s25, s20, 0
  s_lshl_b32 s25, s25, 11
  s_add_u32 s25, s25, s66
  buffer_load_dwordx4 v[12:15], v3, s[4:7], s25 offen offset:0 sc1
  buffer_load_dwordx4 v[16:19], v3, s[4:7], s25 offen offset:1024 sc1
  buffer_load_dwordx4 v[44:47], v3, s[4:7], s65 offen offset:0 sc1
  buffer_load_dwordx4 v[48:51], v3, s[4:7], s65 offen offset:1024 sc1
  s_xor_b32 s25, s20, 1
  s_lshl_b32 s25, s25, 11
  s_add_u32 s25, s25, s66
  buffer_load_dwordx4 v[20:23], v3, s[4:7], s25 offen offset:0 sc1
  buffer_load_dwordx4 v[24:27], v3, s[4:7], s25 offen offset:1024 sc1
  buffer_load_dwordx4 v[52:55], v3, s[8:11], s74 offen offset:0 sc1
  buffer_load_dwordx4 v[56:59], v3, s[8:11], s74 offen offset:1024 sc1
  s_xor_b32 s25, s20, 2
  s_lshl_b32 s25, s25, 11
  s_add_u32 s25, s25, s66
  buffer_load_dwordx4 v[28:31], v3, s[4:7], s25 offen offset:0 sc1
  buffer_load_dwordx4 v[32:35], v3, s[4:7], s25 offen offset:1024 sc1
  s_xor_b32 s25, s20, 3
  s_lshl_b32 s25, s25, 11
  s_add_u32 s25, s25, s66
  buffer_load_dwordx4 v[36:39], v3, s[4:7], s25 offen offset:0 sc1
  buffer_load_dwordx4 v[40:43], v3, s[4:7], s25 offen offset:1024 sc1
  s_waitcnt vmcnt(8)
  v_mfma_f32_32x32x16_bf16 v[108:123], v[44:47], v[12:15], 0
  v_mfma_f32_32x32x16_bf16 v[108:123], v[48:51], v[16:19], v[108:123]
  s_waitcnt vmcnt(6)
  v_mfma_f32_32x32x16_bf16 v[124:139], v[44:47], v[20:23], 0
  buffer_load_dwordx4 v[60:63], v3, s[4:7], s65 offen offset:2048 sc1
  buffer_load_dwordx4 v[64:67], v3, s[4:7], s65 offen offset:3072 sc1
  s_nop 7
  v_exp_f32 v108, v108
  v_exp_f32 v109, v109
  v_exp_f32 v110, v110
  v_exp_f32 v111, v111
  v_cvt_pk_bf16_f32 v140, v108, v109
  v_exp_f32 v112, v112
  buffer_load_dwordx4 v[68:71], v3, s[8:11], s74 offen offset:2048 sc1
  buffer_load_dwordx4 v[72:75], v3, s[8:11], s74 offen offset:3072 sc1
  v_exp_f32 v113, v113
  v_cvt_pk_bf16_f32 v141, v110, v111
  v_exp_f32 v114, v114
  v_exp_f32 v115, v115
  v_cvt_pk_bf16_f32 v142, v112, v113
  v_exp_f32 v116, v116
  v_mfma_f32_32x32x16_bf16 v[124:139], v[48:51], v[24:27], v[124:139]
  s_add_u32 s65, s65, 4096
  s_add_u32 s74, s74, 4096
  v_exp_f32 v117, v117
  v_cvt_pk_bf16_f32 v143, v114, v115
  v_exp_f32 v118, v118
  v_exp_f32 v119, v119
  v_cvt_pk_bf16_f32 v144, v116, v117
  v_exp_f32 v120, v120
  buffer_load_dwordx4 v[76:79], v3, s[4:7], s65 offen offset:0 sc1
  buffer_load_dwordx4 v[80:83], v3, s[4:7], s65 offen offset:1024 sc1
  v_exp_f32 v121, v121
  v_cvt_pk_bf16_f32 v145, v118, v119
  v_exp_f32 v122, v122
  v_exp_f32 v123, v123
  v_cvt_pk_bf16_f32 v146, v120, v121
  v_cvt_pk_bf16_f32 v147, v122, v123
  s_waitcnt vmcnt(8)
  v_mfma_f32_32x32x16_bf16 v[108:123], v[44:47], v[28:31], 0
  buffer_load_dwordx4 v[84:87], v3, s[8:11], s74 offen offset:0 sc1
  buffer_load_dwordx4 v[88:91], v3, s[8:11], s74 offen offset:1024 sc1
  v_exp_f32 v124, v124
  v_exp_f32 v125, v125
  v_exp_f32 v126, v126
  v_exp_f32 v127, v127
  v_cvt_pk_bf16_f32 v148, v124, v125
  v_exp_f32 v128, v128
  s_waitcnt vmcnt(12)
  v_mfma_f32_32x32x16_bf16 v[156:171], v[52:55], v[140:143], v[156:171]
  buffer_load_dwordx4 v[92:95], v3, s[4:7], s65 offen offset:2048 sc1
  buffer_load_dwordx4 v[96:99], v3, s[4:7], s65 offen offset:3072 sc1
  v_exp_f32 v129, v129
  v_cvt_pk_bf16_f32 v149, v126, v127
  v_exp_f32 v130, v130
  v_exp_f32 v131, v131
  v_cvt_pk_bf16_f32 v150, v128, v129
  v_exp_f32 v132, v132
  v_mfma_f32_32x32x16_bf16 v[108:123], v[48:51], v[32:35], v[108:123]
  s_add_u32 s65, s65, 4096
  buffer_load_dwordx4 v[100:103], v3, s[8:11], s74 offen offset:2048 sc1
  v_exp_f32 v133, v133
  v_cvt_pk_bf16_f32 v151, v130, v131
  v_exp_f32 v134, v134
  v_exp_f32 v135, v135
  v_cvt_pk_bf16_f32 v152, v132, v133
  v_exp_f32 v136, v136
  v_mfma_f32_32x32x16_bf16 v[156:171], v[56:59], v[144:147], v[156:171]
  buffer_load_dwordx4 v[104:107], v3, s[8:11], s74 offen offset:3072 sc1
  v_exp_f32 v137, v137
  v_cvt_pk_bf16_f32 v153, v134, v135
  v_exp_f32 v138, v138
  v_exp_f32 v139, v139
  v_cvt_pk_bf16_f32 v154, v136, v137
  v_cvt_pk_bf16_f32 v155, v138, v139
  s_waitcnt vmcnt(12)
  v_mfma_f32_32x32x16_bf16 v[124:139], v[44:47], v[36:39], 0
  s_add_u32 s74, s74, 4096
  v_exp_f32 v108, v108
  v_exp_f32 v109, v109
  v_exp_f32 v110, v110
  v_exp_f32 v111, v111
  v_cvt_pk_bf16_f32 v140, v108, v109
  v_exp_f32 v112, v112
  v_mfma_f32_32x32x16_bf16 v[172:187], v[52:55], v[148:151], v[172:187]
  s_add_u32 m0, s57, 0
  s_mov_b32 s58, 0
  v_exp_f32 v113, v113
  v_cvt_pk_bf16_f32 v141, v110, v111
  v_exp_f32 v114, v114
  v_exp_f32 v115, v115
  v_cvt_pk_bf16_f32 v142, v112, v113
  v_exp_f32 v116, v116
  v_mfma_f32_32x32x16_bf16 v[124:139], v[48:51], v[40:43], v[124:139]
  buffer_load_dwordx4 v9, s[76:79], s58 offen lds
  v_exp_f32 v117, v117
  v_cvt_pk_bf16_f32 v143, v114, v115
  v_exp_f32 v118, v118
  v_exp_f32 v119, v119
  v_cvt_pk_bf16_f32 v144, v116, v117
  v_exp_f32 v120, v120
  v_mfma_f32_32x32x16_bf16 v[172:187], v[56:59], v[152:155], v[172:187]
  buffer_load_dwordx4 v[44:47], v3, s[4:7], s65 offen offset:0 sc1
  v_exp_f32 v121, v121
  v_cvt_pk_bf16_f32 v145, v118, v119
  v_exp_f32 v122, v122
  v_exp_f32 v123, v123
  v_cvt_pk_bf16_f32 v146, v120, v121
  v_cvt_pk_bf16_f32 v147, v122, v123
  s_waitcnt vmcnt(12)
  v_mfma_f32_32x32x16_bf16 v[108:123], v[60:63], v[12:15], 0
  buffer_load_dwordx4 v[48:51], v3, s[4:7], s65 offen offset:1024 sc1
  v_exp_f32 v124, v124
  v_exp_f32 v125, v125
  v_exp_f32 v126, v126
  v_exp_f32 v127, v127
  v_cvt_pk_bf16_f32 v148, v124, v125
  v_exp_f32 v128, v128
  v_mfma_f32_32x32x16_bf16 v[188:203], v[52:55], v[140:143], v[188:203]
  v_exp_f32 v129, v129
  v_cvt_pk_bf16_f32 v149, v126, v127
  v_exp_f32 v130, v130
  v_exp_f32 v131, v131
  v_cvt_pk_bf16_f32 v150, v128, v129
  v_exp_f32 v132, v132
  v_mfma_f32_32x32x16_bf16 v[108:123], v[64:67], v[16:19], v[108:123]
  v_exp_f32 v133, v133
  v_cvt_pk_bf16_f32 v151, v130, v131
  v_exp_f32 v134, v134
  v_exp_f32 v135, v135
  v_cvt_pk_bf16_f32 v152, v132, v133
  v_exp_f32 v136, v136
  v_mfma_f32_32x32x16_bf16 v[188:203], v[56:59], v[144:147], v[188:203]
  v_exp_f32 v137, v137
  v_cvt_pk_bf16_f32 v153, v134, v135
  v_exp_f32 v138, v138
  v_exp_f32 v139, v139
  v_cvt_pk_bf16_f32 v154, v136, v137
  v_cvt_pk_bf16_f32 v155, v138, v139
  v_mfma_f32_32x32x16_bf16 v[124:139], v[60:63], v[20:23], 0
  v_exp_f32 v108, v108
  v_exp_f32 v109, v109
  v_exp_f32 v110, v110
  v_exp_f32 v111, v111
  v_cvt_pk_bf16_f32 v140, v108, v109
  v_exp_f32 v112, v112
  v_mfma_f32_32x32x16_bf16 v[204:219], v[52:55], v[148:151], v[204:219]
  s_add_u32 m0, s57, 4096
  s_mov_b32 s58, 57344
  v_exp_f32 v113, v113
  v_cvt_pk_bf16_f32 v141, v110, v111
  v_exp_f32 v114, v114
  v_exp_f32 v115, v115
  v_cvt_pk_bf16_f32 v142, v112, v113
  v_exp_f32 v116, v116
  v_mfma_f32_32x32x16_bf16 v[124:139], v[64:67], v[24:27], v[124:139]
  buffer_load_dwordx4 v9, s[76:79], s58 offen lds
  v_exp_f32 v117, v117
  v_cvt_pk_bf16_f32 v143, v114, v115
  v_exp_f32 v118, v118
  v_exp_f32 v119, v119
  v_cvt_pk_bf16_f32 v144, v116, v117
  v_exp_f32 v120, v120
  v_mfma_f32_32x32x16_bf16 v[204:219], v[56:59], v[152:155], v[204:219]
  buffer_load_dwordx4 v[52:55], v3, s[8:11], s74 offen offset:0 sc1
  v_exp_f32 v121, v121
  v_cvt_pk_bf16_f32 v145, v118, v119
  v_exp_f32 v122, v122
  v_exp_f32 v123, v123
  v_cvt_pk_bf16_f32 v146, v120, v121
  v_cvt_pk_bf16_f32 v147, v122, v123
  v_mfma_f32_32x32x16_bf16 v[108:123], v[60:63], v[28:31], 0
  buffer_load_dwordx4 v[56:59], v3, s[8:11], s74 offen offset:1024 sc1
  v_exp_f32 v124, v124
  v_exp_f32 v125, v125
  v_exp_f32 v126, v126
  v_exp_f32 v127, v127
  v_cvt_pk_bf16_f32 v148, v124, v125
  v_exp_f32 v128, v128
  s_waitcnt vmcnt(14)
  v_mfma_f32_32x32x16_bf16 v[156:171], v[68:71], v[140:143], v[156:171]
  v_exp_f32 v129, v129
  v_cvt_pk_bf16_f32 v149, v126, v127
  v_exp_f32 v130, v130
  v_exp_f32 v131, v131
  v_cvt_pk_bf16_f32 v150, v128, v129
  v_exp_f32 v132, v132
  v_mfma_f32_32x32x16_bf16 v[108:123], v[64:67], v[32:35], v[108:123]
  v_exp_f32 v133, v133
  v_cvt_pk_bf16_f32 v151, v130, v131
  v_exp_f32 v134, v134
  v_exp_f32 v135, v135
  v_cvt_pk_bf16_f32 v152, v132, v133
  v_exp_f32 v136, v136
  v_mfma_f32_32x32x16_bf16 v[156:171], v[72:75], v[144:147], v[156:171]
  v_exp_f32 v137, v137
  v_cvt_pk_bf16_f32 v153, v134, v135
  v_exp_f32 v138, v138
  v_exp_f32 v139, v139
  v_cvt_pk_bf16_f32 v154, v136, v137
  v_cvt_pk_bf16_f32 v155, v138, v139
  v_mfma_f32_32x32x16_bf16 v[124:139], v[60:63], v[36:39], 0
  v_exp_f32 v108, v108
  v_exp_f32 v109, v109
  v_exp_f32 v110, v110
  v_exp_f32 v111, v111
  v_cvt_pk_bf16_f32 v140, v108, v109
  v_exp_f32 v112, v112
  v_mfma_f32_32x32x16_bf16 v[172:187], v[68:71], v[148:151], v[172:187]
  s_add_u32 m0, s57, 8192
  s_mov_b32 s58, 114688
  v_exp_f32 v113, v113
  v_cvt_pk_bf16_f32 v141, v110, v111
  v_exp_f32 v114, v114
  v_exp_f32 v115, v115
  v_cvt_pk_bf16_f32 v142, v112, v113
  v_exp_f32 v116, v116
  v_mfma_f32_32x32x16_bf16 v[124:139], v[64:67], v[40:43], v[124:139]
  buffer_load_dwordx4 v9, s[76:79], s58 offen lds
  v_exp_f32 v117, v117
  v_cvt_pk_bf16_f32 v143, v114, v115
  v_exp_f32 v118, v118
  v_exp_f32 v119, v119
  v_cvt_pk_bf16_f32 v144, v116, v117
  v_exp_f32 v120, v120
  v_mfma_f32_32x32x16_bf16 v[172:187], v[72:75], v[152:155], v[172:187]
  buffer_load_dwordx4 v[60:63], v3, s[4:7], s65 offen offset:2048 sc1
  buffer_load_dwordx4 v[64:67], v3, s[4:7], s65 offen offset:3072 sc1
  v_exp_f32 v121, v121
  v_cvt_pk_bf16_f32 v145, v118, v119
  v_exp_f32 v122, v122
  v_exp_f32 v123, v123
  v_cvt_pk_bf16_f32 v146, v120, v121
  v_cvt_pk_bf16_f32 v147, v122, v123
  s_waitcnt vmcnt(15)
  v_mfma_f32_32x32x16_bf16 v[108:123], v[76:79], v[12:15], 0
  s_add_u32 s65, s65, 4096
  v_exp_f32 v124, v124
  v_exp_f32 v125, v125
  v_exp_f32 v126, v126
  v_exp_f32 v127, v127
  v_cvt_pk_bf16_f32 v148, v124, v125
  v_exp_f32 v128, v128
  v_mfma_f32_32x32x16_bf16 v[188:203], v[68:71], v[140:143], v[188:203]
  v_exp_f32 v129, v129
  v_cvt_pk_bf16_f32 v149, v126, v127
  v_exp_f32 v130, v130
  v_exp_f32 v131, v131
  v_cvt_pk_bf16_f32 v150, v128, v129
  v_exp_f32 v132, v132
  v_mfma_f32_32x32x16_bf16 v[108:123], v[80:83], v[16:19], v[108:123]
  v_exp_f32 v133, v133
  v_cvt_pk_bf16_f32 v151, v130, v131
  v_exp_f32 v134, v134
  v_exp_f32 v135, v135
  v_cvt_pk_bf16_f32 v152, v132, v133
  v_exp_f32 v136, v136
  v_mfma_f32_32x32x16_bf16 v[188:203], v[72:75], v[144:147], v[188:203]
  v_exp_f32 v137, v137
  v_cvt_pk_bf16_f32 v153, v134, v135
  v_exp_f32 v138, v138
  v_exp_f32 v139, v139
  v_cvt_pk_bf16_f32 v154, v136, v137
  v_cvt_pk_bf16_f32 v155, v138, v139
  v_mfma_f32_32x32x16_bf16 v[124:139], v[76:79], v[20:23], 0
  v_exp_f32 v108, v108
  v_exp_f32 v109, v109
  v_exp_f32 v110, v110
  v_exp_f32 v111, v111
  v_cvt_pk_bf16_f32 v140, v108, v109
  v_exp_f32 v112, v112
  v_mfma_f32_32x32x16_bf16 v[204:219], v[68:71], v[148:151], v[204:219]
  s_add_u32 m0, s57, 12288
  s_mov_b32 s58, 172032
  v_exp_f32 v113, v113
  v_cvt_pk_bf16_f32 v141, v110, v111
  v_exp_f32 v114, v114
  v_exp_f32 v115, v115
  v_cvt_pk_bf16_f32 v142, v112, v113
  v_exp_f32 v116, v116
  v_mfma_f32_32x32x16_bf16 v[124:139], v[80:83], v[24:27], v[124:139]
  buffer_load_dwordx4 v9, s[76:79], s58 offen lds
  v_exp_f32 v117, v117
  v_cvt_pk_bf16_f32 v143, v114, v115
  v_exp_f32 v118, v118
  v_exp_f32 v119, v119
  v_cvt_pk_bf16_f32 v144, v116, v117
  v_exp_f32 v120, v120
  v_mfma_f32_32x32x16_bf16 v[204:219], v[72:75], v[152:155], v[204:219]
  buffer_load_dwordx4 v[68:71], v3, s[8:11], s74 offen offset:2048 sc1
  buffer_load_dwordx4 v[72:75], v3, s[8:11], s74 offen offset:3072 sc1
  v_exp_f32 v121, v121
  v_cvt_pk_bf16_f32 v145, v118, v119
  v_exp_f32 v122, v122
  v_exp_f32 v123, v123
  v_cvt_pk_bf16_f32 v146, v120, v121
  v_cvt_pk_bf16_f32 v147, v122, v123
  v_mfma_f32_32x32x16_bf16 v[108:123], v[76:79], v[28:31], 0
  s_add_u32 s74, s74, 4096
  v_exp_f32 v124, v124
  v_exp_f32 v125, v125
  v_exp_f32 v126, v126
  v_exp_f32 v127, v127
  v_cvt_pk_bf16_f32 v148, v124, v125
  v_exp_f32 v128, v128
  s_waitcnt vmcnt(16)
  v_mfma_f32_32x32x16_bf16 v[156:171], v[84:87], v[140:143], v[156:171]
  v_exp_f32 v129, v129
  v_cvt_pk_bf16_f32 v149, v126, v127
  v_exp_f32 v130, v130
  v_exp_f32 v131, v131
  v_cvt_pk_bf16_f32 v150, v128, v129
  v_exp_f32 v132, v132
  v_mfma_f32_32x32x16_bf16 v[108:123], v[80:83], v[32:35], v[108:123]
  v_exp_f32 v133, v133
  v_cvt_pk_bf16_f32 v151, v130, v131
  v_exp_f32 v134, v134
  v_exp_f32 v135, v135
  v_cvt_pk_bf16_f32 v152, v132, v133
  v_exp_f32 v136, v136
  v_mfma_f32_32x32x16_bf16 v[156:171], v[88:91], v[144:147], v[156:171]
  v_exp_f32 v137, v137
  v_cvt_pk_bf16_f32 v153, v134, v135
  v_exp_f32 v138, v138
  v_exp_f32 v139, v139
  v_cvt_pk_bf16_f32 v154, v136, v137
  v_cvt_pk_bf16_f32 v155, v138, v139
  v_mfma_f32_32x32x16_bf16 v[124:139], v[76:79], v[36:39], 0
  v_exp_f32 v108, v108
  v_exp_f32 v109, v109
  v_exp_f32 v110, v110
  v_exp_f32 v111, v111
  v_cvt_pk_bf16_f32 v140, v108, v109
  v_exp_f32 v112, v112
  v_mfma_f32_32x32x16_bf16 v[172:187], v[84:87], v[148:151], v[172:187]
  s_add_u32 m0, s57, 16384
  s_mov_b32 s58, 229376
  v_exp_f32 v113, v113
  v_cvt_pk_bf16_f32 v141, v110, v111
  v_exp_f32 v114, v114
  v_exp_f32 v115, v115
  v_cvt_pk_bf16_f32 v142, v112, v113
  v_exp_f32 v116, v116
  v_mfma_f32_32x32x16_bf16 v[124:139], v[80:83], v[40:43], v[124:139]
  buffer_load_dwordx4 v9, s[76:79], s58 offen lds
  v_exp_f32 v117, v117
  v_cvt_pk_bf16_f32 v143, v114, v115
  v_exp_f32 v118, v118
  v_exp_f32 v119, v119
  v_cvt_pk_bf16_f32 v144, v116, v117
  v_exp_f32 v120, v120
  v_mfma_f32_32x32x16_bf16 v[172:187], v[88:91], v[152:155], v[172:187]
  buffer_load_dwordx4 v[76:79], v3, s[4:7], s65 offen offset:0 sc1
  v_exp_f32 v121, v121
  v_cvt_pk_bf16_f32 v145, v118, v119
  v_exp_f32 v122, v122
  v_exp_f32 v123, v123
  v_cvt_pk_bf16_f32 v146, v120, v121
  v_cvt_pk_bf16_f32 v147, v122, v123
  s_waitcnt vmcnt(16)
  v_mfma_f32_32x32x16_bf16 v[108:123], v[92:95], v[12:15], 0
  buffer_load_dwordx4 v[80:83], v3, s[4:7], s65 offen offset:1024 sc1
  v_exp_f32 v124, v124
  v_exp_f32 v125, v125
  v_exp_f32 v126, v126
  v_exp_f32 v127, v127
  v_cvt_pk_bf16_f32 v148, v124, v125
  v_exp_f32 v128, v128
  v_mfma_f32_32x32x16_bf16 v[188:203], v[84:87], v[140:143], v[188:203]
  v_exp_f32 v129, v129
  v_cvt_pk_bf16_f32 v149, v126, v127
  v_exp_f32 v130, v130
  v_exp_f32 v131, v131
  v_cvt_pk_bf16_f32 v150, v128, v129
  v_exp_f32 v132, v132
  v_mfma_f32_32x32x16_bf16 v[108:123], v[96:99], v[16:19], v[108:123]
  v_exp_f32 v133, v133
  v_cvt_pk_bf16_f32 v151, v130, v131
  v_exp_f32 v134, v134
  v_exp_f32 v135, v135
  v_cvt_pk_bf16_f32 v152, v132, v133
  v_exp_f32 v136, v136
  v_mfma_f32_32x32x16_bf16 v[188:203], v[88:91], v[144:147], v[188:203]
  v_exp_f32 v137, v137
  v_cvt_pk_bf16_f32 v153, v134, v135
  v_exp_f32 v138, v138
  v_exp_f32 v139, v139
  v_cvt_pk_bf16_f32 v154, v136, v137
  v_cvt_pk_bf16_f32 v155, v138, v139
  v_mfma_f32_32x32x16_bf16 v[124:139], v[92:95], v[20:23], 0
  v_exp_f32 v108, v108
  v_exp_f32 v109, v109
  v_exp_f32 v110, v110
  v_exp_f32 v111, v111
  v_cvt_pk_bf16_f32 v140, v108, v109
  v_exp_f32 v112, v112
  v_mfma_f32_32x32x16_bf16 v[204:219], v[84:87], v[148:151], v[204:219]
  s_add_u32 m0, s57, 20480
  s_mov_b32 s58, 286720
  v_exp_f32 v113, v113
  v_cvt_pk_bf16_f32 v141, v110, v111
  v_exp_f32 v114, v114
  v_exp_f32 v115, v115
  v_cvt_pk_bf16_f32 v142, v112, v113
  v_exp_f32 v116, v116
  v_mfma_f32_32x32x16_bf16 v[124:139], v[96:99], v[24:27], v[124:139]
  buffer_load_dwordx4 v9, s[76:79], s58 offen lds
  v_exp_f32 v117, v117
  v_cvt_pk_bf16_f32 v143, v114, v115
  v_exp_f32 v118, v118
  v_exp_f32 v119, v119
  v_cvt_pk_bf16_f32 v144, v116, v117
  v_exp_f32 v120, v120
  v_mfma_f32_32x32x16_bf16 v[204:219], v[88:91], v[152:155], v[204:219]
  buffer_load_dwordx4 v[84:87], v3, s[8:11], s74 offen offset:0 sc1
  v_exp_f32 v121, v121
  v_cvt_pk_bf16_f32 v145, v118, v119
  v_exp_f32 v122, v122
  v_exp_f32 v123, v123
  v_cvt_pk_bf16_f32 v146, v120, v121
  v_cvt_pk_bf16_f32 v147, v122, v123
  v_mfma_f32_32x32x16_bf16 v[108:123], v[92:95], v[28:31], 0
  buffer_load_dwordx4 v[88:91], v3, s[8:11], s74 offen offset:1024 sc1
  v_exp_f32 v124, v124
  v_exp_f32 v125, v125
  v_exp_f32 v126, v126
  v_exp_f32 v127, v127
  v_cvt_pk_bf16_f32 v148, v124, v125
  v_exp_f32 v128, v128
  s_waitcnt vmcnt(18)
  v_mfma_f32_32x32x16_bf16 v[156:171], v[100:103], v[140:143], v[156:171]
  v_exp_f32 v129, v129
  v_cvt_pk_bf16_f32 v149, v126, v127
  v_exp_f32 v130, v130
  v_exp_f32 v131, v131
  v_cvt_pk_bf16_f32 v150, v128, v129
  v_exp_f32 v132, v132
  v_mfma_f32_32x32x16_bf16 v[108:123], v[96:99], v[32:35], v[108:123]
  v_exp_f32 v133, v133
  v_cvt_pk_bf16_f32 v151, v130, v131
  v_exp_f32 v134, v134
  v_exp_f32 v135, v135
  v_cvt_pk_bf16_f32 v152, v132, v133
  v_exp_f32 v136, v136
  v_mfma_f32_32x32x16_bf16 v[156:171], v[104:107], v[144:147], v[156:171]
  v_exp_f32 v137, v137
  v_cvt_pk_bf16_f32 v153, v134, v135
  v_exp_f32 v138, v138
  v_exp_f32 v139, v139
  v_cvt_pk_bf16_f32 v154, v136, v137
  v_cvt_pk_bf16_f32 v155, v138, v139
  v_mfma_f32_32x32x16_bf16 v[124:139], v[92:95], v[36:39], 0
  v_exp_f32 v108, v108
  v_exp_f32 v109, v109
  v_exp_f32 v110, v110
  v_exp_f32 v111, v111
  v_cvt_pk_bf16_f32 v140, v108, v109
  v_exp_f32 v112, v112
  v_mfma_f32_32x32x16_bf16 v[172:187], v[100:103], v[148:151], v[172:187]
  s_add_u32 m0, s57, 24576
  s_mov_b32 s58, 344064
  v_exp_f32 v113, v113
  v_cvt_pk_bf16_f32 v141, v110, v111
  v_exp_f32 v114, v114
  v_exp_f32 v115, v115
  v_cvt_pk_bf16_f32 v142, v112, v113
  v_exp_f32 v116, v116
  v_mfma_f32_32x32x16_bf16 v[124:139], v[96:99], v[40:43], v[124:139]
  buffer_load_dwordx4 v9, s[76:79], s58 offen lds
  v_exp_f32 v117, v117
  v_cvt_pk_bf16_f32 v143, v114, v115
  v_exp_f32 v118, v118
  v_exp_f32 v119, v119
  v_cvt_pk_bf16_f32 v144, v116, v117
  v_exp_f32 v120, v120
  v_mfma_f32_32x32x16_bf16 v[172:187], v[104:107], v[152:155], v[172:187]
  buffer_load_dwordx4 v[92:95], v3, s[4:7], s65 offen offset:2048 sc1
  buffer_load_dwordx4 v[96:99], v3, s[4:7], s65 offen offset:3072 sc1
  v_exp_f32 v121, v121
  v_cvt_pk_bf16_f32 v145, v118, v119
  v_exp_f32 v122, v122
  v_exp_f32 v123, v123
  v_cvt_pk_bf16_f32 v146, v120, v121
  v_cvt_pk_bf16_f32 v147, v122, v123
  s_waitcnt vmcnt(18)
  v_mfma_f32_32x32x16_bf16 v[108:123], v[44:47], v[12:15], 0
  s_add_u32 s65, s65, 4096
  v_exp_f32 v124, v124
  v_exp_f32 v125, v125
  v_exp_f32 v126, v126
  v_exp_f32 v127, v127
  v_cvt_pk_bf16_f32 v148, v124, v125
  v_exp_f32 v128, v128
  v_mfma_f32_32x32x16_bf16 v[188:203], v[100:103], v[140:143], v[188:203]
  v_exp_f32 v129, v129
  v_cvt_pk_bf16_f32 v149, v126, v127
  v_exp_f32 v130, v130
  v_exp_f32 v131, v131
  v_cvt_pk_bf16_f32 v150, v128, v129
  v_exp_f32 v132, v132
  v_mfma_f32_32x32x16_bf16 v[108:123], v[48:51], v[16:19], v[108:123]
  v_exp_f32 v133, v133
  v_cvt_pk_bf16_f32 v151, v130, v131
  v_exp_f32 v134, v134
  v_exp_f32 v135, v135
  v_cvt_pk_bf16_f32 v152, v132, v133
  v_exp_f32 v136, v136
  v_mfma_f32_32x32x16_bf16 v[188:203], v[104:107], v[144:147], v[188:203]
  v_exp_f32 v137, v137
  v_cvt_pk_bf16_f32 v153, v134, v135
  v_exp_f32 v138, v138
  v_exp_f32 v139, v139
  v_cvt_pk_bf16_f32 v154, v136, v137
  v_cvt_pk_bf16_f32 v155, v138, v139
  v_mfma_f32_32x32x16_bf16 v[124:139], v[44:47], v[20:23], 0
  v_exp_f32 v108, v108
  v_exp_f32 v109, v109
  v_exp_f32 v110, v110
  v_exp_f32 v111, v111
  v_cvt_pk_bf16_f32 v140, v108, v109
  v_exp_f32 v112, v112
  v_mfma_f32_32x32x16_bf16 v[204:219], v[100:103], v[148:151], v[204:219]
  s_add_u32 m0, s57, 28672
  s_mov_b32 s58, 401408
  v_exp_f32 v113, v113
  v_cvt_pk_bf16_f32 v141, v110, v111
  v_exp_f32 v114, v114
  v_exp_f32 v115, v115
  v_cvt_pk_bf16_f32 v142, v112, v113
  v_exp_f32 v116, v116
  v_mfma_f32_32x32x16_bf16 v[124:139], v[48:51], v[24:27], v[124:139]
  buffer_load_dwordx4 v9, s[76:79], s58 offen lds
  v_exp_f32 v117, v117
  v_cvt_pk_bf16_f32 v143, v114, v115
  v_exp_f32 v118, v118
  v_exp_f32 v119, v119
  v_cvt_pk_bf16_f32 v144, v116, v117
  v_exp_f32 v120, v120
  v_mfma_f32_32x32x16_bf16 v[204:219], v[104:107], v[152:155], v[204:219]
  buffer_load_dwordx4 v[100:103], v3, s[8:11], s74 offen offset:2048 sc1
  buffer_load_dwordx4 v[104:107], v3, s[8:11], s74 offen offset:3072 sc1
  v_exp_f32 v121, v121
  v_cvt_pk_bf16_f32 v145, v118, v119
  v_exp_f32 v122, v122
  v_exp_f32 v123, v123
  v_cvt_pk_bf16_f32 v146, v120, v121
  v_cvt_pk_bf16_f32 v147, v122, v123
  v_mfma_f32_32x32x16_bf16 v[108:123], v[44:47], v[28:31], 0
  s_add_u32 s74, s74, 4096
  v_exp_f32 v124, v124
  v_exp_f32 v125, v125
  v_exp_f32 v126, v126
  v_exp_f32 v127, v127
  v_cvt_pk_bf16_f32 v148, v124, v125
  v_exp_f32 v128, v128
  s_waitcnt vmcnt(18)
  v_mfma_f32_32x32x16_bf16 v[156:171], v[52:55], v[140:143], v[156:171]
  v_exp_f32 v129, v129
  v_cvt_pk_bf16_f32 v149, v126, v127
  v_exp_f32 v130, v130
  v_exp_f32 v131, v131
  v_cvt_pk_bf16_f32 v150, v128, v129
  v_exp_f32 v132, v132
  v_mfma_f32_32x32x16_bf16 v[108:123], v[48:51], v[32:35], v[108:123]
  v_exp_f32 v133, v133
  v_cvt_pk_bf16_f32 v151, v130, v131
  v_exp_f32 v134, v134
  v_exp_f32 v135, v135
  v_cvt_pk_bf16_f32 v152, v132, v133
  v_exp_f32 v136, v136
  v_mfma_f32_32x32x16_bf16 v[156:171], v[56:59], v[144:147], v[156:171]
  v_exp_f32 v137, v137
  v_cvt_pk_bf16_f32 v153, v134, v135
  v_exp_f32 v138, v138
  v_exp_f32 v139, v139
  v_cvt_pk_bf16_f32 v154, v136, v137
  v_cvt_pk_bf16_f32 v155, v138, v139
  v_mfma_f32_32x32x16_bf16 v[124:139], v[44:47], v[36:39], 0
  v_exp_f32 v108, v108
  v_exp_f32 v109, v109
  v_exp_f32 v110, v110
  v_exp_f32 v111, v111
  v_cvt_pk_bf16_f32 v140, v108, v109
  v_exp_f32 v112, v112
  v_mfma_f32_32x32x16_bf16 v[172:187], v[52:55], v[148:151], v[172:187]
  s_add_u32 m0, s57, 32768
  s_mov_b32 s58, 458752
  v_exp_f32 v113, v113
  v_cvt_pk_bf16_f32 v141, v110, v111
  v_exp_f32 v114, v114
  v_exp_f32 v115, v115
  v_cvt_pk_bf16_f32 v142, v112, v113
  v_exp_f32 v116, v116
  v_mfma_f32_32x32x16_bf16 v[124:139], v[48:51], v[40:43], v[124:139]
  buffer_load_dwordx4 v9, s[76:79], s58 offen lds
  v_exp_f32 v117, v117
  v_cvt_pk_bf16_f32 v143, v114, v115
  v_exp_f32 v118, v118
  v_exp_f32 v119, v119
  v_cvt_pk_bf16_f32 v144, v116, v117
  v_exp_f32 v120, v120
  v_mfma_f32_32x32x16_bf16 v[172:187], v[56:59], v[152:155], v[172:187]
  buffer_load_dwordx4 v[44:47], v3, s[4:7], s65 offen offset:0 sc1
  v_exp_f32 v121, v121
  v_cvt_pk_bf16_f32 v145, v118, v119
  v_exp_f32 v122, v122
  v_exp_f32 v123, v123
  v_cvt_pk_bf16_f32 v146, v120, v121
  v_cvt_pk_bf16_f32 v147, v122, v123
  s_waitcnt vmcnt(17)
  v_mfma_f32_32x32x16_bf16 v[108:123], v[60:63], v[12:15], 0
  buffer_load_dwordx4 v[48:51], v3, s[4:7], s65 offen offset:1024 sc1
  v_exp_f32 v124, v124
  v_exp_f32 v125, v125
  v_exp_f32 v126, v126
  v_exp_f32 v127, v127
  v_cvt_pk_bf16_f32 v148, v124, v125
  v_exp_f32 v128, v128
  v_mfma_f32_32x32x16_bf16 v[188:203], v[52:55], v[140:143], v[188:203]
  v_exp_f32 v129, v129
  v_cvt_pk_bf16_f32 v149, v126, v127
  v_exp_f32 v130, v130
  v_exp_f32 v131, v131
  v_cvt_pk_bf16_f32 v150, v128, v129
  v_exp_f32 v132, v132
  v_mfma_f32_32x32x16_bf16 v[108:123], v[64:67], v[16:19], v[108:123]
  v_exp_f32 v133, v133
  v_cvt_pk_bf16_f32 v151, v130, v131
  v_exp_f32 v134, v134
  v_exp_f32 v135, v135
  v_cvt_pk_bf16_f32 v152, v132, v133
  v_exp_f32 v136, v136
  v_mfma_f32_32x32x16_bf16 v[188:203], v[56:59], v[144:147], v[188:203]
  v_exp_f32 v137, v137
  v_cvt_pk_bf16_f32 v153, v134, v135
  v_exp_f32 v138, v138
  v_exp_f32 v139, v139
  v_cvt_pk_bf16_f32 v154, v136, v137
  v_cvt_pk_bf16_f32 v155, v138, v139
  v_mfma_f32_32x32x16_bf16 v[124:139], v[60:63], v[20:23], 0
  v_exp_f32 v108, v108
  v_exp_f32 v109, v109
  v_exp_f32 v110, v110
  v_exp_f32 v111, v111
  v_cvt_pk_bf16_f32 v140, v108, v109
  v_exp_f32 v112, v112
  v_mfma_f32_32x32x16_bf16 v[204:219], v[52:55], v[148:151], v[204:219]
  s_add_u32 m0, s57, 36864
  s_mov_b32 s58, 516096
  v_exp_f32 v113, v113
  v_cvt_pk_bf16_f32 v141, v110, v111
  v_exp_f32 v114, v114
  v_exp_f32 v115, v115
  v_cvt_pk_bf16_f32 v142, v112, v113
  v_exp_f32 v116, v116
  v_mfma_f32_32x32x16_bf16 v[124:139], v[64:67], v[24:27], v[124:139]
  buffer_load_dwordx4 v9, s[76:79], s58 offen lds
  v_exp_f32 v117, v117
  v_cvt_pk_bf16_f32 v143, v114, v115
  v_exp_f32 v118, v118
  v_exp_f32 v119, v119
  v_cvt_pk_bf16_f32 v144, v116, v117
  v_exp_f32 v120, v120
  v_mfma_f32_32x32x16_bf16 v[204:219], v[56:59], v[152:155], v[204:219]
  buffer_load_dwordx4 v[52:55], v3, s[8:11], s74 offen offset:0 sc1
  v_exp_f32 v121, v121
  v_cvt_pk_bf16_f32 v145, v118, v119
  v_exp_f32 v122, v122
  v_exp_f32 v123, v123
  v_cvt_pk_bf16_f32 v146, v120, v121
  v_cvt_pk_bf16_f32 v147, v122, v123
  v_mfma_f32_32x32x16_bf16 v[108:123], v[60:63], v[28:31], 0
  buffer_load_dwordx4 v[56:59], v3, s[8:11], s74 offen offset:1024 sc1
  v_exp_f32 v124, v124
  v_exp_f32 v125, v125
  v_exp_f32 v126, v126
  v_exp_f32 v127, v127
  v_cvt_pk_bf16_f32 v148, v124, v125
  v_exp_f32 v128, v128
  s_waitcnt vmcnt(18)
  v_mfma_f32_32x32x16_bf16 v[156:171], v[68:71], v[140:143], v[156:171]
  v_exp_f32 v129, v129
  v_cvt_pk_bf16_f32 v149, v126, v127
  v_exp_f32 v130, v130
  v_exp_f32 v131, v131
  v_cvt_pk_bf16_f32 v150, v128, v129
  v_exp_f32 v132, v132
  v_mfma_f32_32x32x16_bf16 v[108:123], v[64:67], v[32:35], v[108:123]
  v_exp_f32 v133, v133
  v_cvt_pk_bf16_f32 v151, v130, v131
  v_exp_f32 v134, v134
  v_exp_f32 v135, v135
  v_cvt_pk_bf16_f32 v152, v132, v133
  v_exp_f32 v136, v136
  v_mfma_f32_32x32x16_bf16 v[156:171], v[72:75], v[144:147], v[156:171]
  v_exp_f32 v137, v137
  v_cvt_pk_bf16_f32 v153, v134, v135
  v_exp_f32 v138, v138
  v_exp_f32 v139, v139
  v_cvt_pk_bf16_f32 v154, v136, v137
  v_cvt_pk_bf16_f32 v155, v138, v139
  v_mfma_f32_32x32x16_bf16 v[124:139], v[60:63], v[36:39], 0
  v_exp_f32 v108, v108
  v_exp_f32 v109, v109
  v_exp_f32 v110, v110
  v_exp_f32 v111, v111
  v_cvt_pk_bf16_f32 v140, v108, v109
  v_exp_f32 v112, v112
  v_mfma_f32_32x32x16_bf16 v[172:187], v[68:71], v[148:151], v[172:187]
  s_add_u32 m0, s57, 40960
  s_mov_b32 s58, 573440
  v_exp_f32 v113, v113
  v_cvt_pk_bf16_f32 v141, v110, v111
  v_exp_f32 v114, v114
  v_exp_f32 v115, v115
  v_cvt_pk_bf16_f32 v142, v112, v113
  v_exp_f32 v116, v116
  v_mfma_f32_32x32x16_bf16 v[124:139], v[64:67], v[40:43], v[124:139]
  buffer_load_dwordx4 v9, s[76:79], s58 offen lds
  v_exp_f32 v117, v117
  v_cvt_pk_bf16_f32 v143, v114, v115
  v_exp_f32 v118, v118
  v_exp_f32 v119, v119
  v_cvt_pk_bf16_f32 v144, v116, v117
  v_exp_f32 v120, v120
  v_mfma_f32_32x32x16_bf16 v[172:187], v[72:75], v[152:155], v[172:187]
  buffer_load_dwordx4 v[60:63], v3, s[4:7], s65 offen offset:2048 sc1
  buffer_load_dwordx4 v[64:67], v3, s[4:7], s65 offen offset:3072 sc1
  v_exp_f32 v121, v121
  v_cvt_pk_bf16_f32 v145, v118, v119
  v_exp_f32 v122, v122
  v_exp_f32 v123, v123
  v_cvt_pk_bf16_f32 v146, v120, v121
  v_cvt_pk_bf16_f32 v147, v122, v123
  s_waitcnt vmcnt(18)
  v_mfma_f32_32x32x16_bf16 v[108:123], v[76:79], v[12:15], 0
  s_add_u32 s65, s65, 4096
  v_exp_f32 v124, v124
  v_exp_f32 v125, v125
  v_exp_f32 v126, v126
  v_exp_f32 v127, v127
  v_cvt_pk_bf16_f32 v148, v124, v125
  v_exp_f32 v128, v128
  v_mfma_f32_32x32x16_bf16 v[188:203], v[68:71], v[140:143], v[188:203]
  v_exp_f32 v129, v129
  v_cvt_pk_bf16_f32 v149, v126, v127
  v_exp_f32 v130, v130
  v_exp_f32 v131, v131
  v_cvt_pk_bf16_f32 v150, v128, v129
  v_exp_f32 v132, v132
  v_mfma_f32_32x32x16_bf16 v[108:123], v[80:83], v[16:19], v[108:123]
  v_exp_f32 v133, v133
  v_cvt_pk_bf16_f32 v151, v130, v131
  v_exp_f32 v134, v134
  v_exp_f32 v135, v135
  v_cvt_pk_bf16_f32 v152, v132, v133
  v_exp_f32 v136, v136
  v_mfma_f32_32x32x16_bf16 v[188:203], v[72:75], v[144:147], v[188:203]
  v_exp_f32 v137, v137
  v_cvt_pk_bf16_f32 v153, v134, v135
  v_exp_f32 v138, v138
  v_exp_f32 v139, v139
  v_cvt_pk_bf16_f32 v154, v136, v137
  v_cvt_pk_bf16_f32 v155, v138, v139
  v_mfma_f32_32x32x16_bf16 v[124:139], v[76:79], v[20:23], 0
  v_exp_f32 v108, v108
  v_exp_f32 v109, v109
  v_exp_f32 v110, v110
  v_exp_f32 v111, v111
  v_cvt_pk_bf16_f32 v140, v108, v109
  v_exp_f32 v112, v112
  v_mfma_f32_32x32x16_bf16 v[204:219], v[68:71], v[148:151], v[204:219]
  s_add_u32 m0, s57, 45056
  s_mov_b32 s58, 630784
  v_exp_f32 v113, v113
  v_cvt_pk_bf16_f32 v141, v110, v111
  v_exp_f32 v114, v114
  v_exp_f32 v115, v115
  v_cvt_pk_bf16_f32 v142, v112, v113
  v_exp_f32 v116, v116
  v_mfma_f32_32x32x16_bf16 v[124:139], v[80:83], v[24:27], v[124:139]
  buffer_load_dwordx4 v9, s[76:79], s58 offen lds
  v_exp_f32 v117, v117
  v_cvt_pk_bf16_f32 v143, v114, v115
  v_exp_f32 v118, v118
  v_exp_f32 v119, v119
  v_cvt_pk_bf16_f32 v144, v116, v117
  v_exp_f32 v120, v120
  v_mfma_f32_32x32x16_bf16 v[204:219], v[72:75], v[152:155], v[204:219]
  buffer_load_dwordx4 v[68:71], v3, s[8:11], s74 offen offset:2048 sc1
  buffer_load_dwordx4 v[72:75], v3, s[8:11], s74 offen offset:3072 sc1
  v_exp_f32 v121, v121
  v_cvt_pk_bf16_f32 v145, v118, v119
  v_exp_f32 v122, v122
  v_exp_f32 v123, v123
  v_cvt_pk_bf16_f32 v146, v120, v121
  v_cvt_pk_bf16_f32 v147, v122, v123
  v_mfma_f32_32x32x16_bf16 v[108:123], v[76:79], v[28:31], 0
  s_add_u32 s74, s74, 4096
  v_exp_f32 v124, v124
  v_exp_f32 v125, v125
  v_exp_f32 v126, v126
  v_exp_f32 v127, v127
  v_cvt_pk_bf16_f32 v148, v124, v125
  v_exp_f32 v128, v128
  s_waitcnt vmcnt(18)
  v_mfma_f32_32x32x16_bf16 v[156:171], v[84:87], v[140:143], v[156:171]
  v_exp_f32 v129, v129
  v_cvt_pk_bf16_f32 v149, v126, v127
  v_exp_f32 v130, v130
  v_exp_f32 v131, v131
  v_cvt_pk_bf16_f32 v150, v128, v129
  v_exp_f32 v132, v132
  v_mfma_f32_32x32x16_bf16 v[108:123], v[80:83], v[32:35], v[108:123]
  v_exp_f32 v133, v133
  v_cvt_pk_bf16_f32 v151, v130, v131
  v_exp_f32 v134, v134
  v_exp_f32 v135, v135
  v_cvt_pk_bf16_f32 v152, v132, v133
  v_exp_f32 v136, v136
  v_mfma_f32_32x32x16_bf16 v[156:171], v[88:91], v[144:147], v[156:171]
  v_exp_f32 v137, v137
  v_cvt_pk_bf16_f32 v153, v134, v135
  v_exp_f32 v138, v138
  v_exp_f32 v139, v139
  v_cvt_pk_bf16_f32 v154, v136, v137
  v_cvt_pk_bf16_f32 v155, v138, v139
  v_mfma_f32_32x32x16_bf16 v[124:139], v[76:79], v[36:39], 0
  v_exp_f32 v108, v108
  v_exp_f32 v109, v109
  v_exp_f32 v110, v110
  v_exp_f32 v111, v111
  v_cvt_pk_bf16_f32 v140, v108, v109
  v_exp_f32 v112, v112
  v_mfma_f32_32x32x16_bf16 v[172:187], v[84:87], v[148:151], v[172:187]
  s_add_u32 m0, s57, 49152
  s_mov_b32 s58, 688128
  v_exp_f32 v113, v113
  v_cvt_pk_bf16_f32 v141, v110, v111
  v_exp_f32 v114, v114
  v_exp_f32 v115, v115
  v_cvt_pk_bf16_f32 v142, v112, v113
  v_exp_f32 v116, v116
  v_mfma_f32_32x32x16_bf16 v[124:139], v[80:83], v[40:43], v[124:139]
  buffer_load_dwordx4 v9, s[76:79], s58 offen lds
  v_exp_f32 v117, v117
  v_cvt_pk_bf16_f32 v143, v114, v115
  v_exp_f32 v118, v118
  v_exp_f32 v119, v119
  v_cvt_pk_bf16_f32 v144, v116, v117
  v_exp_f32 v120, v120
  v_mfma_f32_32x32x16_bf16 v[172:187], v[88:91], v[152:155], v[172:187]
  buffer_load_dwordx4 v[76:79], v3, s[4:7], s65 offen offset:0 sc1
  v_exp_f32 v121, v121
  v_cvt_pk_bf16_f32 v145, v118, v119
  v_exp_f32 v122, v122
  v_exp_f32 v123, v123
  v_cvt_pk_bf16_f32 v146, v120, v121
  v_cvt_pk_bf16_f32 v147, v122, v123
  s_waitcnt vmcnt(17)
  v_mfma_f32_32x32x16_bf16 v[108:123], v[92:95], v[12:15], 0
  buffer_load_dwordx4 v[80:83], v3, s[4:7], s65 offen offset:1024 sc1
  v_exp_f32 v124, v124
  v_exp_f32 v125, v125
  v_exp_f32 v126, v126
  v_exp_f32 v127, v127
  v_cvt_pk_bf16_f32 v148, v124, v125
  v_exp_f32 v128, v128
  v_mfma_f32_32x32x16_bf16 v[188:203], v[84:87], v[140:143], v[188:203]
  v_exp_f32 v129, v129
  v_cvt_pk_bf16_f32 v149, v126, v127
  v_exp_f32 v130, v130
  v_exp_f32 v131, v131
  v_cvt_pk_bf16_f32 v150, v128, v129
  v_exp_f32 v132, v132
  v_mfma_f32_32x32x16_bf16 v[108:123], v[96:99], v[16:19], v[108:123]
  v_exp_f32 v133, v133
  v_cvt_pk_bf16_f32 v151, v130, v131
  v_exp_f32 v134, v134
  v_exp_f32 v135, v135
  v_cvt_pk_bf16_f32 v152, v132, v133
  v_exp_f32 v136, v136
  v_mfma_f32_32x32x16_bf16 v[188:203], v[88:91], v[144:147], v[188:203]
  v_exp_f32 v137, v137
  v_cvt_pk_bf16_f32 v153, v134, v135
  v_exp_f32 v138, v138
  v_exp_f32 v139, v139
  v_cvt_pk_bf16_f32 v154, v136, v137
  v_cvt_pk_bf16_f32 v155, v138, v139
  v_mfma_f32_32x32x16_bf16 v[124:139], v[92:95], v[20:23], 0
  v_exp_f32 v108, v108
  v_exp_f32 v109, v109
  v_exp_f32 v110, v110
  v_exp_f32 v111, v111
  v_cvt_pk_bf16_f32 v140, v108, v109
  v_exp_f32 v112, v112
  v_mfma_f32_32x32x16_bf16 v[204:219], v[84:87], v[148:151], v[204:219]
  s_add_u32 m0, s57, 53248
  s_mov_b32 s58, 745472
  v_exp_f32 v113, v113
  v_cvt_pk_bf16_f32 v141, v110, v111
  v_exp_f32 v114, v114
  v_exp_f32 v115, v115
  v_cvt_pk_bf16_f32 v142, v112, v113
  v_exp_f32 v116, v116
  v_mfma_f32_32x32x16_bf16 v[124:139], v[96:99], v[24:27], v[124:139]
  buffer_load_dwordx4 v9, s[76:79], s58 offen lds
  v_exp_f32 v117, v117
  v_cvt_pk_bf16_f32 v143, v114, v115
  v_exp_f32 v118, v118
  v_exp_f32 v119, v119
  v_cvt_pk_bf16_f32 v144, v116, v117
  v_exp_f32 v120, v120
  v_mfma_f32_32x32x16_bf16 v[204:219], v[88:91], v[152:155], v[204:219]
  buffer_load_dwordx4 v[84:87], v3, s[8:11], s74 offen offset:0 sc1
  v_exp_f32 v121, v121
  v_cvt_pk_bf16_f32 v145, v118, v119
  v_exp_f32 v122, v122
  v_exp_f32 v123, v123
  v_cvt_pk_bf16_f32 v146, v120, v121
  v_cvt_pk_bf16_f32 v147, v122, v123
  v_mfma_f32_32x32x16_bf16 v[108:123], v[92:95], v[28:31], 0
  buffer_load_dwordx4 v[88:91], v3, s[8:11], s74 offen offset:1024 sc1
  v_exp_f32 v124, v124
  v_exp_f32 v125, v125
  v_exp_f32 v126, v126
  v_exp_f32 v127, v127
  v_cvt_pk_bf16_f32 v148, v124, v125
  v_exp_f32 v128, v128
  s_waitcnt vmcnt(18)
  v_mfma_f32_32x32x16_bf16 v[156:171], v[100:103], v[140:143], v[156:171]
  v_exp_f32 v129, v129
  v_cvt_pk_bf16_f32 v149, v126, v127
  v_exp_f32 v130, v130
  v_exp_f32 v131, v131
  v_cvt_pk_bf16_f32 v150, v128, v129
  v_exp_f32 v132, v132
  v_mfma_f32_32x32x16_bf16 v[108:123], v[96:99], v[32:35], v[108:123]
  v_exp_f32 v133, v133
  v_cvt_pk_bf16_f32 v151, v130, v131
  v_exp_f32 v134, v134
  v_exp_f32 v135, v135
  v_cvt_pk_bf16_f32 v152, v132, v133
  v_exp_f32 v136, v136
  v_mfma_f32_32x32x16_bf16 v[156:171], v[104:107], v[144:147], v[156:171]
  v_exp_f32 v137, v137
  v_cvt_pk_bf16_f32 v153, v134, v135
  v_exp_f32 v138, v138
  v_exp_f32 v139, v139
  v_cvt_pk_bf16_f32 v154, v136, v137
  v_cvt_pk_bf16_f32 v155, v138, v139
  v_mfma_f32_32x32x16_bf16 v[124:139], v[92:95], v[36:39], 0
  v_exp_f32 v108, v108
  v_exp_f32 v109, v109
  v_exp_f32 v110, v110
  v_exp_f32 v111, v111
  v_cvt_pk_bf16_f32 v140, v108, v109
  v_exp_f32 v112, v112
  v_mfma_f32_32x32x16_bf16 v[172:187], v[100:103], v[148:151], v[172:187]
  s_add_u32 m0, s57, 57344
  s_mov_b32 s58, 802816
  v_exp_f32 v113, v113
  v_cvt_pk_bf16_f32 v141, v110, v111
  v_exp_f32 v114, v114
  v_exp_f32 v115, v115
  v_cvt_pk_bf16_f32 v142, v112, v113
  v_exp_f32 v116, v116
  v_mfma_f32_32x32x16_bf16 v[124:139], v[96:99], v[40:43], v[124:139]
  buffer_load_dwordx4 v9, s[76:79], s58 offen lds
  v_exp_f32 v117, v117
  v_cvt_pk_bf16_f32 v143, v114, v115
  v_exp_f32 v118, v118
  v_exp_f32 v119, v119
  v_cvt_pk_bf16_f32 v144, v116, v117
  v_exp_f32 v120, v120
  v_mfma_f32_32x32x16_bf16 v[172:187], v[104:107], v[152:155], v[172:187]
  buffer_load_dwordx4 v[92:95], v3, s[4:7], s65 offen offset:2048 sc1
  buffer_load_dwordx4 v[96:99], v3, s[4:7], s65 offen offset:3072 sc1
  v_exp_f32 v121, v121
  v_cvt_pk_bf16_f32 v145, v118, v119
  v_exp_f32 v122, v122
  v_exp_f32 v123, v123
  v_cvt_pk_bf16_f32 v146, v120, v121
  v_cvt_pk_bf16_f32 v147, v122, v123
  s_waitcnt vmcnt(18)
  v_mfma_f32_32x32x16_bf16 v[108:123], v[44:47], v[12:15], 0
  s_add_u32 s65, s65, 4096
  v_exp_f32 v124, v124
  v_exp_f32 v125, v125
  v_exp_f32 v126, v126
  v_exp_f32 v127, v127
  v_cvt_pk_bf16_f32 v148, v124, v125
  v_exp_f32 v128, v128
  v_mfma_f32_32x32x16_bf16 v[188:203], v[100:103], v[140:143], v[188:203]
  v_exp_f32 v129, v129
  v_cvt_pk_bf16_f32 v149, v126, v127
  v_exp_f32 v130, v130
  v_exp_f32 v131, v131
  v_cvt_pk_bf16_f32 v150, v128, v129
  v_exp_f32 v132, v132
  v_mfma_f32_32x32x16_bf16 v[108:123], v[48:51], v[16:19], v[108:123]
  v_exp_f32 v133, v133
  v_cvt_pk_bf16_f32 v151, v130, v131
  v_exp_f32 v134, v134
  v_exp_f32 v135, v135
  v_cvt_pk_bf16_f32 v152, v132, v133
  v_exp_f32 v136, v136
  v_mfma_f32_32x32x16_bf16 v[188:203], v[104:107], v[144:147], v[188:203]
  v_exp_f32 v137, v137
  v_cvt_pk_bf16_f32 v153, v134, v135
  v_exp_f32 v138, v138
  v_exp_f32 v139, v139
  v_cvt_pk_bf16_f32 v154, v136, v137
  v_cvt_pk_bf16_f32 v155, v138, v139
  v_mfma_f32_32x32x16_bf16 v[124:139], v[44:47], v[20:23], 0
  v_exp_f32 v108, v108
  v_exp_f32 v109, v109
  v_exp_f32 v110, v110
  v_exp_f32 v111, v111
  v_cvt_pk_bf16_f32 v140, v108, v109
  v_exp_f32 v112, v112
  v_mfma_f32_32x32x16_bf16 v[204:219], v[100:103], v[148:151], v[204:219]
  s_add_u32 m0, s57, 61440
  s_mov_b32 s58, 860160
  v_exp_f32 v113, v113
  v_cvt_pk_bf16_f32 v141, v110, v111
  v_exp_f32 v114, v114
  v_exp_f32 v115, v115
  v_cvt_pk_bf16_f32 v142, v112, v113
  v_exp_f32 v116, v116
  v_mfma_f32_32x32x16_bf16 v[124:139], v[48:51], v[24:27], v[124:139]
  buffer_load_dwordx4 v9, s[76:79], s58 offen lds
  v_exp_f32 v117, v117
  v_cvt_pk_bf16_f32 v143, v114, v115
  v_exp_f32 v118, v118
  v_exp_f32 v119, v119
  v_cvt_pk_bf16_f32 v144, v116, v117
  v_exp_f32 v120, v120
  v_mfma_f32_32x32x16_bf16 v[204:219], v[104:107], v[152:155], v[204:219]
  buffer_load_dwordx4 v[100:103], v3, s[8:11], s74 offen offset:2048 sc1
  buffer_load_dwordx4 v[104:107], v3, s[8:11], s74 offen offset:3072 sc1
  v_exp_f32 v121, v121
  v_cvt_pk_bf16_f32 v145, v118, v119
  v_exp_f32 v122, v122
  v_exp_f32 v123, v123
  v_cvt_pk_bf16_f32 v146, v120, v121
  v_cvt_pk_bf16_f32 v147, v122, v123
  v_mfma_f32_32x32x16_bf16 v[108:123], v[44:47], v[28:31], 0
  s_add_u32 s74, s74, 4096
  v_exp_f32 v124, v124
  v_exp_f32 v125, v125
  v_exp_f32 v126, v126
  v_exp_f32 v127, v127
  v_cvt_pk_bf16_f32 v148, v124, v125
  v_exp_f32 v128, v128
  s_waitcnt vmcnt(18)
  v_mfma_f32_32x32x16_bf16 v[156:171], v[52:55], v[140:143], v[156:171]
  v_exp_f32 v129, v129
  v_cvt_pk_bf16_f32 v149, v126, v127
  v_exp_f32 v130, v130
  v_exp_f32 v131, v131
  v_cvt_pk_bf16_f32 v150, v128, v129
  v_exp_f32 v132, v132
  v_mfma_f32_32x32x16_bf16 v[108:123], v[48:51], v[32:35], v[108:123]
  v_exp_f32 v133, v133
  v_cvt_pk_bf16_f32 v151, v130, v131
  v_exp_f32 v134, v134
  v_exp_f32 v135, v135
  v_cvt_pk_bf16_f32 v152, v132, v133
  v_exp_f32 v136, v136
  v_mfma_f32_32x32x16_bf16 v[156:171], v[56:59], v[144:147], v[156:171]
  v_exp_f32 v137, v137
  v_cvt_pk_bf16_f32 v153, v134, v135
  v_exp_f32 v138, v138
  v_exp_f32 v139, v139
  v_cvt_pk_bf16_f32 v154, v136, v137
  v_cvt_pk_bf16_f32 v155, v138, v139
  v_mfma_f32_32x32x16_bf16 v[124:139], v[44:47], v[36:39], 0
  v_exp_f32 v108, v108
  v_exp_f32 v109, v109
  v_exp_f32 v110, v110
  v_exp_f32 v111, v111
  v_cvt_pk_bf16_f32 v140, v108, v109
  v_exp_f32 v112, v112
  v_mfma_f32_32x32x16_bf16 v[172:187], v[52:55], v[148:151], v[172:187]
  s_add_u32 m0, s57, 65536
  s_mov_b32 s58, 917504
  v_exp_f32 v113, v113
  v_cvt_pk_bf16_f32 v141, v110, v111
  v_exp_f32 v114, v114
  v_exp_f32 v115, v115
  v_cvt_pk_bf16_f32 v142, v112, v113
  v_exp_f32 v116, v116
  v_mfma_f32_32x32x16_bf16 v[124:139], v[48:51], v[40:43], v[124:139]
  buffer_load_dwordx4 v9, s[76:79], s58 offen lds
  v_exp_f32 v117, v117
  v_cvt_pk_bf16_f32 v143, v114, v115
  v_exp_f32 v118, v118
  v_exp_f32 v119, v119
  v_cvt_pk_bf16_f32 v144, v116, v117
  v_exp_f32 v120, v120
  v_mfma_f32_32x32x16_bf16 v[172:187], v[56:59], v[152:155], v[172:187]
  buffer_load_dwordx4 v[44:47], v3, s[4:7], s65 offen offset:0 sc1
  v_exp_f32 v121, v121
  v_cvt_pk_bf16_f32 v145, v118, v119
  v_exp_f32 v122, v122
  v_exp_f32 v123, v123
  v_cvt_pk_bf16_f32 v146, v120, v121
  v_cvt_pk_bf16_f32 v147, v122, v123
  s_waitcnt vmcnt(17)
  v_mfma_f32_32x32x16_bf16 v[108:123], v[60:63], v[12:15], 0
  buffer_load_dwordx4 v[48:51], v3, s[4:7], s65 offen offset:1024 sc1
  v_exp_f32 v124, v124
  v_exp_f32 v125, v125
  v_exp_f32 v126, v126
  v_exp_f32 v127, v127
  v_cvt_pk_bf16_f32 v148, v124, v125
  v_exp_f32 v128, v128
  v_mfma_f32_32x32x16_bf16 v[188:203], v[52:55], v[140:143], v[188:203]
  v_exp_f32 v129, v129
  v_cvt_pk_bf16_f32 v149, v126, v127
  v_exp_f32 v130, v130
  v_exp_f32 v131, v131
  v_cvt_pk_bf16_f32 v150, v128, v129
  v_exp_f32 v132, v132
  v_mfma_f32_32x32x16_bf16 v[108:123], v[64:67], v[16:19], v[108:123]
  v_exp_f32 v133, v133
  v_cvt_pk_bf16_f32 v151, v130, v131
  v_exp_f32 v134, v134
  v_exp_f32 v135, v135
  v_cvt_pk_bf16_f32 v152, v132, v133
  v_exp_f32 v136, v136
  v_mfma_f32_32x32x16_bf16 v[188:203], v[56:59], v[144:147], v[188:203]
  v_exp_f32 v137, v137
  v_cvt_pk_bf16_f32 v153, v134, v135
  v_exp_f32 v138, v138
  v_exp_f32 v139, v139
  v_cvt_pk_bf16_f32 v154, v136, v137
  v_cvt_pk_bf16_f32 v155, v138, v139
  v_mfma_f32_32x32x16_bf16 v[124:139], v[60:63], v[20:23], 0
  v_exp_f32 v108, v108
  v_exp_f32 v109, v109
  v_exp_f32 v110, v110
  v_exp_f32 v111, v111
  v_cvt_pk_bf16_f32 v140, v108, v109
  v_exp_f32 v112, v112
  v_mfma_f32_32x32x16_bf16 v[204:219], v[52:55], v[148:151], v[204:219]
  s_add_u32 m0, s57, 69632
  s_mov_b32 s58, 974848
  v_exp_f32 v113, v113
  v_cvt_pk_bf16_f32 v141, v110, v111
  v_exp_f32 v114, v114
  v_exp_f32 v115, v115
  v_cvt_pk_bf16_f32 v142, v112, v113
  v_exp_f32 v116, v116
  v_mfma_f32_32x32x16_bf16 v[124:139], v[64:67], v[24:27], v[124:139]
  buffer_load_dwordx4 v9, s[76:79], s58 offen lds
  v_exp_f32 v117, v117
  v_cvt_pk_bf16_f32 v143, v114, v115
  v_exp_f32 v118, v118
  v_exp_f32 v119, v119
  v_cvt_pk_bf16_f32 v144, v116, v117
  v_exp_f32 v120, v120
  v_mfma_f32_32x32x16_bf16 v[204:219], v[56:59], v[152:155], v[204:219]
  buffer_load_dwordx4 v[52:55], v3, s[8:11], s74 offen offset:0 sc1
  v_exp_f32 v121, v121
  v_cvt_pk_bf16_f32 v145, v118, v119
  v_exp_f32 v122, v122
  v_exp_f32 v123, v123
  v_cvt_pk_bf16_f32 v146, v120, v121
  v_cvt_pk_bf16_f32 v147, v122, v123
  v_mfma_f32_32x32x16_bf16 v[108:123], v[60:63], v[28:31], 0
  buffer_load_dwordx4 v[56:59], v3, s[8:11], s74 offen offset:1024 sc1
  v_exp_f32 v124, v124
  v_exp_f32 v125, v125
  v_exp_f32 v126, v126
  v_exp_f32 v127, v127
  v_cvt_pk_bf16_f32 v148, v124, v125
  v_exp_f32 v128, v128
  s_waitcnt vmcnt(18)
  v_mfma_f32_32x32x16_bf16 v[156:171], v[68:71], v[140:143], v[156:171]
  v_exp_f32 v129, v129
  v_cvt_pk_bf16_f32 v149, v126, v127
  v_exp_f32 v130, v130
  v_exp_f32 v131, v131
  v_cvt_pk_bf16_f32 v150, v128, v129
  v_exp_f32 v132, v132
  v_mfma_f32_32x32x16_bf16 v[108:123], v[64:67], v[32:35], v[108:123]
  v_exp_f32 v133, v133
  v_cvt_pk_bf16_f32 v151, v130, v131
  v_exp_f32 v134, v134
  v_exp_f32 v135, v135
  v_cvt_pk_bf16_f32 v152, v132, v133
  v_exp_f32 v136, v136
  v_mfma_f32_32x32x16_bf16 v[156:171], v[72:75], v[144:147], v[156:171]
  v_exp_f32 v137, v137
  v_cvt_pk_bf16_f32 v153, v134, v135
  v_exp_f32 v138, v138
  v_exp_f32 v139, v139
  v_cvt_pk_bf16_f32 v154, v136, v137
  v_cvt_pk_bf16_f32 v155, v138, v139
  v_mfma_f32_32x32x16_bf16 v[124:139], v[60:63], v[36:39], 0
  v_exp_f32 v108, v108
  v_exp_f32 v109, v109
  v_exp_f32 v110, v110
  v_exp_f32 v111, v111
  v_cvt_pk_bf16_f32 v140, v108, v109
  v_exp_f32 v112, v112
  v_mfma_f32_32x32x16_bf16 v[172:187], v[68:71], v[148:151], v[172:187]
  s_add_u32 m0, s57, 73728
  s_mov_b32 s58, 1032192
  v_exp_f32 v113, v113
  v_cvt_pk_bf16_f32 v141, v110, v111
  v_exp_f32 v114, v114
  v_exp_f32 v115, v115
  v_cvt_pk_bf16_f32 v142, v112, v113
  v_exp_f32 v116, v116
  v_mfma_f32_32x32x16_bf16 v[124:139], v[64:67], v[40:43], v[124:139]
  buffer_load_dwordx4 v9, s[76:79], s58 offen lds
  v_exp_f32 v117, v117
  v_cvt_pk_bf16_f32 v143, v114, v115
  v_exp_f32 v118, v118
  v_exp_f32 v119, v119
  v_cvt_pk_bf16_f32 v144, v116, v117
  v_exp_f32 v120, v120
  v_mfma_f32_32x32x16_bf16 v[172:187], v[72:75], v[152:155], v[172:187]
  buffer_load_dwordx4 v[60:63], v3, s[4:7], s65 offen offset:2048 sc1
  buffer_load_dwordx4 v[64:67], v3, s[4:7], s65 offen offset:3072 sc1
  v_exp_f32 v121, v121
  v_cvt_pk_bf16_f32 v145, v118, v119
  v_exp_f32 v122, v122
  v_exp_f32 v123, v123
  v_cvt_pk_bf16_f32 v146, v120, v121
  v_cvt_pk_bf16_f32 v147, v122, v123
  s_waitcnt vmcnt(18)
  v_mfma_f32_32x32x16_bf16 v[108:123], v[76:79], v[12:15], 0
  s_add_u32 s65, s65, 4096
  v_exp_f32 v124, v124
  v_exp_f32 v125, v125
  v_exp_f32 v126, v126
  v_exp_f32 v127, v127
  v_cvt_pk_bf16_f32 v148, v124, v125
  v_exp_f32 v128, v128
  v_mfma_f32_32x32x16_bf16 v[188:203], v[68:71], v[140:143], v[188:203]
  v_exp_f32 v129, v129
  v_cvt_pk_bf16_f32 v149, v126, v127
  v_exp_f32 v130, v130
  v_exp_f32 v131, v131
  v_cvt_pk_bf16_f32 v150, v128, v129
  v_exp_f32 v132, v132
  v_mfma_f32_32x32x16_bf16 v[108:123], v[80:83], v[16:19], v[108:123]
  v_exp_f32 v133, v133
  v_cvt_pk_bf16_f32 v151, v130, v131
  v_exp_f32 v134, v134
  v_exp_f32 v135, v135
  v_cvt_pk_bf16_f32 v152, v132, v133
  v_exp_f32 v136, v136
  v_mfma_f32_32x32x16_bf16 v[188:203], v[72:75], v[144:147], v[188:203]
  v_exp_f32 v137, v137
  v_cvt_pk_bf16_f32 v153, v134, v135
  v_exp_f32 v138, v138
  v_exp_f32 v139, v139
  v_cvt_pk_bf16_f32 v154, v136, v137
  v_cvt_pk_bf16_f32 v155, v138, v139
  v_mfma_f32_32x32x16_bf16 v[124:139], v[76:79], v[20:23], 0
  v_exp_f32 v108, v108
  v_exp_f32 v109, v109
  v_exp_f32 v110, v110
  v_exp_f32 v111, v111
  v_cvt_pk_bf16_f32 v140, v108, v109
  v_exp_f32 v112, v112
  v_mfma_f32_32x32x16_bf16 v[204:219], v[68:71], v[148:151], v[204:219]
  s_add_u32 m0, s57, 77824
  s_mov_b32 s58, 1089536
  v_exp_f32 v113, v113
  v_cvt_pk_bf16_f32 v141, v110, v111
  v_exp_f32 v114, v114
  v_exp_f32 v115, v115
  v_cvt_pk_bf16_f32 v142, v112, v113
  v_exp_f32 v116, v116
  v_mfma_f32_32x32x16_bf16 v[124:139], v[80:83], v[24:27], v[124:139]
  buffer_load_dwordx4 v9, s[76:79], s58 offen lds
  v_exp_f32 v117, v117
  v_cvt_pk_bf16_f32 v143, v114, v115
  v_exp_f32 v118, v118
  v_exp_f32 v119, v119
  v_cvt_pk_bf16_f32 v144, v116, v117
  v_exp_f32 v120, v120
  v_mfma_f32_32x32x16_bf16 v[204:219], v[72:75], v[152:155], v[204:219]
  buffer_load_dwordx4 v[68:71], v3, s[8:11], s74 offen offset:2048 sc1
  buffer_load_dwordx4 v[72:75], v3, s[8:11], s74 offen offset:3072 sc1
  v_exp_f32 v121, v121
  v_cvt_pk_bf16_f32 v145, v118, v119
  v_exp_f32 v122, v122
  v_exp_f32 v123, v123
  v_cvt_pk_bf16_f32 v146, v120, v121
  v_cvt_pk_bf16_f32 v147, v122, v123
  v_mfma_f32_32x32x16_bf16 v[108:123], v[76:79], v[28:31], 0
  s_add_u32 s74, s74, 4096
  v_exp_f32 v124, v124
  v_exp_f32 v125, v125
  v_exp_f32 v126, v126
  v_exp_f32 v127, v127
  v_cvt_pk_bf16_f32 v148, v124, v125
  v_exp_f32 v128, v128
  s_waitcnt vmcnt(18)
  v_mfma_f32_32x32x16_bf16 v[156:171], v[84:87], v[140:143], v[156:171]
  v_exp_f32 v129, v129
  v_cvt_pk_bf16_f32 v149, v126, v127
  v_exp_f32 v130, v130
  v_exp_f32 v131, v131
  v_cvt_pk_bf16_f32 v150, v128, v129
  v_exp_f32 v132, v132
  v_mfma_f32_32x32x16_bf16 v[108:123], v[80:83], v[32:35], v[108:123]
  v_exp_f32 v133, v133
  v_cvt_pk_bf16_f32 v151, v130, v131
  v_exp_f32 v134, v134
  v_exp_f32 v135, v135
  v_cvt_pk_bf16_f32 v152, v132, v133
  v_exp_f32 v136, v136
  v_mfma_f32_32x32x16_bf16 v[156:171], v[88:91], v[144:147], v[156:171]
  v_exp_f32 v137, v137
  v_cvt_pk_bf16_f32 v153, v134, v135
  v_exp_f32 v138, v138
  v_exp_f32 v139, v139
  v_cvt_pk_bf16_f32 v154, v136, v137
  v_cvt_pk_bf16_f32 v155, v138, v139
  v_mfma_f32_32x32x16_bf16 v[124:139], v[76:79], v[36:39], 0
  v_exp_f32 v108, v108
  v_exp_f32 v109, v109
  v_exp_f32 v110, v110
  v_exp_f32 v111, v111
  v_cvt_pk_bf16_f32 v140, v108, v109
  v_exp_f32 v112, v112
  v_mfma_f32_32x32x16_bf16 v[172:187], v[84:87], v[148:151], v[172:187]
  s_add_u32 m0, s57, 81920
  s_mov_b32 s58, 1146880
  v_exp_f32 v113, v113
  v_cvt_pk_bf16_f32 v141, v110, v111
  v_exp_f32 v114, v114
  v_exp_f32 v115, v115
  v_cvt_pk_bf16_f32 v142, v112, v113
  v_exp_f32 v116, v116
  v_mfma_f32_32x32x16_bf16 v[124:139], v[80:83], v[40:43], v[124:139]
  buffer_load_dwordx4 v9, s[76:79], s58 offen lds
  v_exp_f32 v117, v117
  v_cvt_pk_bf16_f32 v143, v114, v115
  v_exp_f32 v118, v118
  v_exp_f32 v119, v119
  v_cvt_pk_bf16_f32 v144, v116, v117
  v_exp_f32 v120, v120
  v_mfma_f32_32x32x16_bf16 v[172:187], v[88:91], v[152:155], v[172:187]
  buffer_load_dwordx4 v[76:79], v3, s[4:7], s65 offen offset:0 sc1
  v_exp_f32 v121, v121
  v_cvt_pk_bf16_f32 v145, v118, v119
  v_exp_f32 v122, v122
  v_exp_f32 v123, v123
  v_cvt_pk_bf16_f32 v146, v120, v121
  v_cvt_pk_bf16_f32 v147, v122, v123
  s_waitcnt vmcnt(17)
  v_mfma_f32_32x32x16_bf16 v[108:123], v[92:95], v[12:15], 0
  buffer_load_dwordx4 v[80:83], v3, s[4:7], s65 offen offset:1024 sc1
  v_exp_f32 v124, v124
  v_exp_f32 v125, v125
  v_exp_f32 v126, v126
  v_exp_f32 v127, v127
  v_cvt_pk_bf16_f32 v148, v124, v125
  v_exp_f32 v128, v128
  v_mfma_f32_32x32x16_bf16 v[188:203], v[84:87], v[140:143], v[188:203]
  v_exp_f32 v129, v129
  v_cvt_pk_bf16_f32 v149, v126, v127
  v_exp_f32 v130, v130
  v_exp_f32 v131, v131
  v_cvt_pk_bf16_f32 v150, v128, v129
  v_exp_f32 v132, v132
  v_mfma_f32_32x32x16_bf16 v[108:123], v[96:99], v[16:19], v[108:123]
  v_exp_f32 v133, v133
  v_cvt_pk_bf16_f32 v151, v130, v131
  v_exp_f32 v134, v134
  v_exp_f32 v135, v135
  v_cvt_pk_bf16_f32 v152, v132, v133
  v_exp_f32 v136, v136
  v_mfma_f32_32x32x16_bf16 v[188:203], v[88:91], v[144:147], v[188:203]
  v_exp_f32 v137, v137
  v_cvt_pk_bf16_f32 v153, v134, v135
  v_exp_f32 v138, v138
  v_exp_f32 v139, v139
  v_cvt_pk_bf16_f32 v154, v136, v137
  v_cvt_pk_bf16_f32 v155, v138, v139
  v_mfma_f32_32x32x16_bf16 v[124:139], v[92:95], v[20:23], 0
  v_exp_f32 v108, v108
  v_exp_f32 v109, v109
  v_exp_f32 v110, v110
  v_exp_f32 v111, v111
  v_cvt_pk_bf16_f32 v140, v108, v109
  v_exp_f32 v112, v112
  v_mfma_f32_32x32x16_bf16 v[204:219], v[84:87], v[148:151], v[204:219]
  s_add_u32 m0, s57, 86016
  s_mov_b32 s58, 1204224
  v_exp_f32 v113, v113
  v_cvt_pk_bf16_f32 v141, v110, v111
  v_exp_f32 v114, v114
  v_exp_f32 v115, v115
  v_cvt_pk_bf16_f32 v142, v112, v113
  v_exp_f32 v116, v116
  v_mfma_f32_32x32x16_bf16 v[124:139], v[96:99], v[24:27], v[124:139]
  buffer_load_dwordx4 v9, s[76:79], s58 offen lds
  v_exp_f32 v117, v117
  v_cvt_pk_bf16_f32 v143, v114, v115
  v_exp_f32 v118, v118
  v_exp_f32 v119, v119
  v_cvt_pk_bf16_f32 v144, v116, v117
  v_exp_f32 v120, v120
  v_mfma_f32_32x32x16_bf16 v[204:219], v[88:91], v[152:155], v[204:219]
  buffer_load_dwordx4 v[84:87], v3, s[8:11], s74 offen offset:0 sc1
  v_exp_f32 v121, v121
  v_cvt_pk_bf16_f32 v145, v118, v119
  v_exp_f32 v122, v122
  v_exp_f32 v123, v123
  v_cvt_pk_bf16_f32 v146, v120, v121
  v_cvt_pk_bf16_f32 v147, v122, v123
  v_mfma_f32_32x32x16_bf16 v[108:123], v[92:95], v[28:31], 0
  buffer_load_dwordx4 v[88:91], v3, s[8:11], s74 offen offset:1024 sc1
  v_exp_f32 v124, v124
  v_exp_f32 v125, v125
  v_exp_f32 v126, v126
  v_exp_f32 v127, v127
  v_cvt_pk_bf16_f32 v148, v124, v125
  v_exp_f32 v128, v128
  s_waitcnt vmcnt(18)
  v_mfma_f32_32x32x16_bf16 v[156:171], v[100:103], v[140:143], v[156:171]
  v_exp_f32 v129, v129
  v_cvt_pk_bf16_f32 v149, v126, v127
  v_exp_f32 v130, v130
  v_exp_f32 v131, v131
  v_cvt_pk_bf16_f32 v150, v128, v129
  v_exp_f32 v132, v132
  v_mfma_f32_32x32x16_bf16 v[108:123], v[96:99], v[32:35], v[108:123]
  v_exp_f32 v133, v133
  v_cvt_pk_bf16_f32 v151, v130, v131
  v_exp_f32 v134, v134
  v_exp_f32 v135, v135
  v_cvt_pk_bf16_f32 v152, v132, v133
  v_exp_f32 v136, v136
  v_mfma_f32_32x32x16_bf16 v[156:171], v[104:107], v[144:147], v[156:171]
  v_exp_f32 v137, v137
  v_cvt_pk_bf16_f32 v153, v134, v135
  v_exp_f32 v138, v138
  v_exp_f32 v139, v139
  v_cvt_pk_bf16_f32 v154, v136, v137
  v_cvt_pk_bf16_f32 v155, v138, v139
  v_mfma_f32_32x32x16_bf16 v[124:139], v[92:95], v[36:39], 0
  v_exp_f32 v108, v108
  v_exp_f32 v109, v109
  v_exp_f32 v110, v110
  v_exp_f32 v111, v111
  v_cvt_pk_bf16_f32 v140, v108, v109
  v_exp_f32 v112, v112
  v_mfma_f32_32x32x16_bf16 v[172:187], v[100:103], v[148:151], v[172:187]
  s_add_u32 m0, s57, 90112
  s_mov_b32 s58, 1261568
  v_exp_f32 v113, v113
  v_cvt_pk_bf16_f32 v141, v110, v111
  v_exp_f32 v114, v114
  v_exp_f32 v115, v115
  v_cvt_pk_bf16_f32 v142, v112, v113
  v_exp_f32 v116, v116
  v_mfma_f32_32x32x16_bf16 v[124:139], v[96:99], v[40:43], v[124:139]
  buffer_load_dwordx4 v9, s[76:79], s58 offen lds
  v_exp_f32 v117, v117
  v_cvt_pk_bf16_f32 v143, v114, v115
  v_exp_f32 v118, v118
  v_exp_f32 v119, v119
  v_cvt_pk_bf16_f32 v144, v116, v117
  v_exp_f32 v120, v120
  v_mfma_f32_32x32x16_bf16 v[172:187], v[104:107], v[152:155], v[172:187]
  buffer_load_dwordx4 v[92:95], v3, s[4:7], s65 offen offset:2048 sc1
  buffer_load_dwordx4 v[96:99], v3, s[4:7], s65 offen offset:3072 sc1
  v_exp_f32 v121, v121
  v_cvt_pk_bf16_f32 v145, v118, v119
  v_exp_f32 v122, v122
  v_exp_f32 v123, v123
  v_cvt_pk_bf16_f32 v146, v120, v121
  v_cvt_pk_bf16_f32 v147, v122, v123
  s_waitcnt vmcnt(18)
  v_mfma_f32_32x32x16_bf16 v[108:123], v[44:47], v[12:15], 0
  s_add_u32 s65, s65, 4096
  v_exp_f32 v124, v124
  v_exp_f32 v125, v125
  v_exp_f32 v126, v126
  v_exp_f32 v127, v127
  v_cvt_pk_bf16_f32 v148, v124, v125
  v_exp_f32 v128, v128
  v_mfma_f32_32x32x16_bf16 v[188:203], v[100:103], v[140:143], v[188:203]
  v_exp_f32 v129, v129
  v_cvt_pk_bf16_f32 v149, v126, v127
  v_exp_f32 v130, v130
  v_exp_f32 v131, v131
  v_cvt_pk_bf16_f32 v150, v128, v129
  v_exp_f32 v132, v132
  v_mfma_f32_32x32x16_bf16 v[108:123], v[48:51], v[16:19], v[108:123]
  v_exp_f32 v133, v133
  v_cvt_pk_bf16_f32 v151, v130, v131
  v_exp_f32 v134, v134
  v_exp_f32 v135, v135
  v_cvt_pk_bf16_f32 v152, v132, v133
  v_exp_f32 v136, v136
  v_mfma_f32_32x32x16_bf16 v[188:203], v[104:107], v[144:147], v[188:203]
  v_exp_f32 v137, v137
  v_cvt_pk_bf16_f32 v153, v134, v135
  v_exp_f32 v138, v138
  v_exp_f32 v139, v139
  v_cvt_pk_bf16_f32 v154, v136, v137
  v_cvt_pk_bf16_f32 v155, v138, v139
  v_mfma_f32_32x32x16_bf16 v[124:139], v[44:47], v[20:23], 0
  v_exp_f32 v108, v108
  v_exp_f32 v109, v109
  v_exp_f32 v110, v110
  v_exp_f32 v111, v111
  v_cvt_pk_bf16_f32 v140, v108, v109
  v_exp_f32 v112, v112
  v_mfma_f32_32x32x16_bf16 v[204:219], v[100:103], v[148:151], v[204:219]
  s_add_u32 m0, s57, 94208
  s_mov_b32 s58, 1318912
  v_exp_f32 v113, v113
  v_cvt_pk_bf16_f32 v141, v110, v111
  v_exp_f32 v114, v114
  v_exp_f32 v115, v115
  v_cvt_pk_bf16_f32 v142, v112, v113
  v_exp_f32 v116, v116
  v_mfma_f32_32x32x16_bf16 v[124:139], v[48:51], v[24:27], v[124:139]
  buffer_load_dwordx4 v9, s[76:79], s58 offen lds
  v_exp_f32 v117, v117
  v_cvt_pk_bf16_f32 v143, v114, v115
  v_exp_f32 v118, v118
  v_exp_f32 v119, v119
  v_cvt_pk_bf16_f32 v144, v116, v117
  v_exp_f32 v120, v120
  v_mfma_f32_32x32x16_bf16 v[204:219], v[104:107], v[152:155], v[204:219]
  buffer_load_dwordx4 v[100:103], v3, s[8:11], s74 offen offset:2048 sc1
  buffer_load_dwordx4 v[104:107], v3, s[8:11], s74 offen offset:3072 sc1
  v_exp_f32 v121, v121
  v_cvt_pk_bf16_f32 v145, v118, v119
  v_exp_f32 v122, v122
  v_exp_f32 v123, v123
  v_cvt_pk_bf16_f32 v146, v120, v121
  v_cvt_pk_bf16_f32 v147, v122, v123
  v_mfma_f32_32x32x16_bf16 v[108:123], v[44:47], v[28:31], 0
  s_add_u32 s74, s74, 4096
  v_exp_f32 v124, v124
  v_exp_f32 v125, v125
  v_exp_f32 v126, v126
  v_exp_f32 v127, v127
  v_cvt_pk_bf16_f32 v148, v124, v125
  v_exp_f32 v128, v128
  s_waitcnt vmcnt(18)
  v_mfma_f32_32x32x16_bf16 v[156:171], v[52:55], v[140:143], v[156:171]
  v_exp_f32 v129, v129
  v_cvt_pk_bf16_f32 v149, v126, v127
  v_exp_f32 v130, v130
  v_exp_f32 v131, v131
  v_cvt_pk_bf16_f32 v150, v128, v129
  v_exp_f32 v132, v132
  v_mfma_f32_32x32x16_bf16 v[108:123], v[48:51], v[32:35], v[108:123]
  v_exp_f32 v133, v133
  v_cvt_pk_bf16_f32 v151, v130, v131
  v_exp_f32 v134, v134
  v_exp_f32 v135, v135
  v_cvt_pk_bf16_f32 v152, v132, v133
  v_exp_f32 v136, v136
  v_mfma_f32_32x32x16_bf16 v[156:171], v[56:59], v[144:147], v[156:171]
  v_exp_f32 v137, v137
  v_cvt_pk_bf16_f32 v153, v134, v135
  v_exp_f32 v138, v138
  v_exp_f32 v139, v139
  v_cvt_pk_bf16_f32 v154, v136, v137
  v_cvt_pk_bf16_f32 v155, v138, v139
  v_mfma_f32_32x32x16_bf16 v[124:139], v[44:47], v[36:39], 0
  v_exp_f32 v108, v108
  v_exp_f32 v109, v109
  v_exp_f32 v110, v110
  v_exp_f32 v111, v111
  v_cvt_pk_bf16_f32 v140, v108, v109
  v_exp_f32 v112, v112
  v_mfma_f32_32x32x16_bf16 v[172:187], v[52:55], v[148:151], v[172:187]
  s_add_u32 m0, s57, 98304
  s_mov_b32 s58, 1376256
  v_exp_f32 v113, v113
  v_cvt_pk_bf16_f32 v141, v110, v111
  v_exp_f32 v114, v114
  v_exp_f32 v115, v115
  v_cvt_pk_bf16_f32 v142, v112, v113
  v_exp_f32 v116, v116
  v_mfma_f32_32x32x16_bf16 v[124:139], v[48:51], v[40:43], v[124:139]
  buffer_load_dwordx4 v9, s[76:79], s58 offen lds
  v_exp_f32 v117, v117
  v_cvt_pk_bf16_f32 v143, v114, v115
  v_exp_f32 v118, v118
  v_exp_f32 v119, v119
  v_cvt_pk_bf16_f32 v144, v116, v117
  v_exp_f32 v120, v120
  v_mfma_f32_32x32x16_bf16 v[172:187], v[56:59], v[152:155], v[172:187]
  v_exp_f32 v121, v121
  v_cvt_pk_bf16_f32 v145, v118, v119
  v_exp_f32 v122, v122
  v_exp_f32 v123, v123
  v_cvt_pk_bf16_f32 v146, v120, v121
  v_cvt_pk_bf16_f32 v147, v122, v123
  s_waitcnt vmcnt(16)
  v_mfma_f32_32x32x16_bf16 v[108:123], v[60:63], v[12:15], 0
  v_exp_f32 v124, v124
  v_exp_f32 v125, v125
  v_exp_f32 v126, v126
  v_exp_f32 v127, v127
  v_cvt_pk_bf16_f32 v148, v124, v125
  v_exp_f32 v128, v128
  v_mfma_f32_32x32x16_bf16 v[188:203], v[52:55], v[140:143], v[188:203]
  v_exp_f32 v129, v129
  v_cvt_pk_bf16_f32 v149, v126, v127
  v_exp_f32 v130, v130
  v_exp_f32 v131, v131
  v_cvt_pk_bf16_f32 v150, v128, v129
  v_exp_f32 v132, v132
  v_mfma_f32_32x32x16_bf16 v[108:123], v[64:67], v[16:19], v[108:123]
  v_exp_f32 v133, v133
  v_cvt_pk_bf16_f32 v151, v130, v131
  v_exp_f32 v134, v134
  v_exp_f32 v135, v135
  v_cvt_pk_bf16_f32 v152, v132, v133
  v_exp_f32 v136, v136
  v_mfma_f32_32x32x16_bf16 v[188:203], v[56:59], v[144:147], v[188:203]
  v_exp_f32 v137, v137
  v_cvt_pk_bf16_f32 v153, v134, v135
  v_exp_f32 v138, v138
  v_exp_f32 v139, v139
  v_cvt_pk_bf16_f32 v154, v136, v137
  v_cvt_pk_bf16_f32 v155, v138, v139
  v_mfma_f32_32x32x16_bf16 v[124:139], v[60:63], v[20:23], 0
  v_exp_f32 v108, v108
  v_exp_f32 v109, v109
  v_exp_f32 v110, v110
  v_exp_f32 v111, v111
  v_cvt_pk_bf16_f32 v140, v108, v109
  v_exp_f32 v112, v112
  v_mfma_f32_32x32x16_bf16 v[204:219], v[52:55], v[148:151], v[204:219]
  s_add_u32 m0, s57, 102400
  s_mov_b32 s58, 1433600
  v_exp_f32 v113, v113
  v_cvt_pk_bf16_f32 v141, v110, v111
  v_exp_f32 v114, v114
  v_exp_f32 v115, v115
  v_cvt_pk_bf16_f32 v142, v112, v113
  v_exp_f32 v116, v116
  v_mfma_f32_32x32x16_bf16 v[124:139], v[64:67], v[24:27], v[124:139]
  buffer_load_dwordx4 v9, s[76:79], s58 offen lds
  v_exp_f32 v117, v117
  v_cvt_pk_bf16_f32 v143, v114, v115
  v_exp_f32 v118, v118
  v_exp_f32 v119, v119
  v_cvt_pk_bf16_f32 v144, v116, v117
  v_exp_f32 v120, v120
  v_mfma_f32_32x32x16_bf16 v[204:219], v[56:59], v[152:155], v[204:219]
  v_exp_f32 v121, v121
  v_cvt_pk_bf16_f32 v145, v118, v119
  v_exp_f32 v122, v122
  v_exp_f32 v123, v123
  v_cvt_pk_bf16_f32 v146, v120, v121
  v_cvt_pk_bf16_f32 v147, v122, v123
  v_mfma_f32_32x32x16_bf16 v[108:123], v[60:63], v[28:31], 0
  v_exp_f32 v124, v124
  v_exp_f32 v125, v125
  v_exp_f32 v126, v126
  v_exp_f32 v127, v127
  v_cvt_pk_bf16_f32 v148, v124, v125
  v_exp_f32 v128, v128
  s_waitcnt vmcnt(14)
  v_mfma_f32_32x32x16_bf16 v[156:171], v[68:71], v[140:143], v[156:171]
  v_exp_f32 v129, v129
  v_cvt_pk_bf16_f32 v149, v126, v127
  v_exp_f32 v130, v130
  v_exp_f32 v131, v131
  v_cvt_pk_bf16_f32 v150, v128, v129
  v_exp_f32 v132, v132
  v_mfma_f32_32x32x16_bf16 v[108:123], v[64:67], v[32:35], v[108:123]
  v_exp_f32 v133, v133
  v_cvt_pk_bf16_f32 v151, v130, v131
  v_exp_f32 v134, v134
  v_exp_f32 v135, v135
  v_cvt_pk_bf16_f32 v152, v132, v133
  v_exp_f32 v136, v136
  v_mfma_f32_32x32x16_bf16 v[156:171], v[72:75], v[144:147], v[156:171]
  v_exp_f32 v137, v137
  v_cvt_pk_bf16_f32 v153, v134, v135
  v_exp_f32 v138, v138
  v_exp_f32 v139, v139
  v_cvt_pk_bf16_f32 v154, v136, v137
  v_cvt_pk_bf16_f32 v155, v138, v139
  v_mfma_f32_32x32x16_bf16 v[124:139], v[60:63], v[36:39], 0
  v_exp_f32 v108, v108
  v_exp_f32 v109, v109
  v_exp_f32 v110, v110
  v_exp_f32 v111, v111
  v_cvt_pk_bf16_f32 v140, v108, v109
  v_exp_f32 v112, v112
  v_mfma_f32_32x32x16_bf16 v[172:187], v[68:71], v[148:151], v[172:187]
  s_add_u32 m0, s57, 106496
  s_mov_b32 s58, 1490944
  v_exp_f32 v113, v113
  v_cvt_pk_bf16_f32 v141, v110, v111
  v_exp_f32 v114, v114
  v_exp_f32 v115, v115
  v_cvt_pk_bf16_f32 v142, v112, v113
  v_exp_f32 v116, v116
  v_mfma_f32_32x32x16_bf16 v[124:139], v[64:67], v[40:43], v[124:139]
  buffer_load_dwordx4 v9, s[76:79], s58 offen lds
  v_exp_f32 v117, v117
  v_cvt_pk_bf16_f32 v143, v114, v115
  v_exp_f32 v118, v118
  v_exp_f32 v119, v119
  v_cvt_pk_bf16_f32 v144, v116, v117
  v_exp_f32 v120, v120
  v_mfma_f32_32x32x16_bf16 v[172:187], v[72:75], v[152:155], v[172:187]
  v_exp_f32 v121, v121
  v_cvt_pk_bf16_f32 v145, v118, v119
  v_exp_f32 v122, v122
  v_exp_f32 v123, v123
  v_cvt_pk_bf16_f32 v146, v120, v121
  v_cvt_pk_bf16_f32 v147, v122, v123
  s_waitcnt vmcnt(12)
  v_mfma_f32_32x32x16_bf16 v[108:123], v[76:79], v[12:15], 0
  v_exp_f32 v124, v124
  v_exp_f32 v125, v125
  v_exp_f32 v126, v126
  v_exp_f32 v127, v127
  v_cvt_pk_bf16_f32 v148, v124, v125
  v_exp_f32 v128, v128
  v_mfma_f32_32x32x16_bf16 v[188:203], v[68:71], v[140:143], v[188:203]
  v_exp_f32 v129, v129
  v_cvt_pk_bf16_f32 v149, v126, v127
  v_exp_f32 v130, v130
  v_exp_f32 v131, v131
  v_cvt_pk_bf16_f32 v150, v128, v129
  v_exp_f32 v132, v132
  v_mfma_f32_32x32x16_bf16 v[108:123], v[80:83], v[16:19], v[108:123]
  v_exp_f32 v133, v133
  v_cvt_pk_bf16_f32 v151, v130, v131
  v_exp_f32 v134, v134
  v_exp_f32 v135, v135
  v_cvt_pk_bf16_f32 v152, v132, v133
  v_exp_f32 v136, v136
  v_mfma_f32_32x32x16_bf16 v[188:203], v[72:75], v[144:147], v[188:203]
  v_exp_f32 v137, v137
  v_cvt_pk_bf16_f32 v153, v134, v135
  v_exp_f32 v138, v138
  v_exp_f32 v139, v139
  v_cvt_pk_bf16_f32 v154, v136, v137
  v_cvt_pk_bf16_f32 v155, v138, v139
  v_mfma_f32_32x32x16_bf16 v[124:139], v[76:79], v[20:23], 0
  v_exp_f32 v108, v108
  v_exp_f32 v109, v109
  v_exp_f32 v110, v110
  v_exp_f32 v111, v111
  v_cvt_pk_bf16_f32 v140, v108, v109
  v_exp_f32 v112, v112
  v_mfma_f32_32x32x16_bf16 v[204:219], v[68:71], v[148:151], v[204:219]
  s_add_u32 m0, s57, 110592
  s_mov_b32 s58, 1548288
  v_exp_f32 v113, v113
  v_cvt_pk_bf16_f32 v141, v110, v111
  v_exp_f32 v114, v114
  v_exp_f32 v115, v115
  v_cvt_pk_bf16_f32 v142, v112, v113
  v_exp_f32 v116, v116
  v_mfma_f32_32x32x16_bf16 v[124:139], v[80:83], v[24:27], v[124:139]
  buffer_load_dwordx4 v9, s[76:79], s58 offen lds
  v_exp_f32 v117, v117
  v_cvt_pk_bf16_f32 v143, v114, v115
  v_exp_f32 v118, v118
  v_exp_f32 v119, v119
  v_cvt_pk_bf16_f32 v144, v116, v117
  v_exp_f32 v120, v120
  v_mfma_f32_32x32x16_bf16 v[204:219], v[72:75], v[152:155], v[204:219]
  v_exp_f32 v121, v121
  v_cvt_pk_bf16_f32 v145, v118, v119
  v_exp_f32 v122, v122
  v_exp_f32 v123, v123
  v_cvt_pk_bf16_f32 v146, v120, v121
  v_cvt_pk_bf16_f32 v147, v122, v123
  v_mfma_f32_32x32x16_bf16 v[108:123], v[76:79], v[28:31], 0
  v_exp_f32 v124, v124
  v_exp_f32 v125, v125
  v_exp_f32 v126, v126
  v_exp_f32 v127, v127
  v_cvt_pk_bf16_f32 v148, v124, v125
  v_exp_f32 v128, v128
  s_waitcnt vmcnt(10)
  v_mfma_f32_32x32x16_bf16 v[156:171], v[84:87], v[140:143], v[156:171]
  v_exp_f32 v129, v129
  v_cvt_pk_bf16_f32 v149, v126, v127
  v_exp_f32 v130, v130
  v_exp_f32 v131, v131
  v_cvt_pk_bf16_f32 v150, v128, v129
  v_exp_f32 v132, v132
  v_mfma_f32_32x32x16_bf16 v[108:123], v[80:83], v[32:35], v[108:123]
  v_exp_f32 v133, v133
  v_cvt_pk_bf16_f32 v151, v130, v131
  v_exp_f32 v134, v134
  v_exp_f32 v135, v135
  v_cvt_pk_bf16_f32 v152, v132, v133
  v_exp_f32 v136, v136
  v_mfma_f32_32x32x16_bf16 v[156:171], v[88:91], v[144:147], v[156:171]
  v_exp_f32 v137, v137
  v_cvt_pk_bf16_f32 v153, v134, v135
  v_exp_f32 v138, v138
  v_exp_f32 v139, v139
  v_cvt_pk_bf16_f32 v154, v136, v137
  v_cvt_pk_bf16_f32 v155, v138, v139
  v_mfma_f32_32x32x16_bf16 v[124:139], v[76:79], v[36:39], 0
  v_exp_f32 v108, v108
  v_exp_f32 v109, v109
  v_exp_f32 v110, v110
  v_exp_f32 v111, v111
  v_cvt_pk_bf16_f32 v140, v108, v109
  v_exp_f32 v112, v112
  v_mfma_f32_32x32x16_bf16 v[172:187], v[84:87], v[148:151], v[172:187]
  v_exp_f32 v113, v113
  v_cvt_pk_bf16_f32 v141, v110, v111
  v_exp_f32 v114, v114
  v_exp_f32 v115, v115
  v_cvt_pk_bf16_f32 v142, v112, v113
  v_exp_f32 v116, v116
  v_mfma_f32_32x32x16_bf16 v[124:139], v[80:83], v[40:43], v[124:139]
  v_exp_f32 v117, v117
  v_cvt_pk_bf16_f32 v143, v114, v115
  v_exp_f32 v118, v118
  v_exp_f32 v119, v119
  v_cvt_pk_bf16_f32 v144, v116, v117
  v_exp_f32 v120, v120
  v_mfma_f32_32x32x16_bf16 v[172:187], v[88:91], v[152:155], v[172:187]
  v_exp_f32 v121, v121
  v_cvt_pk_bf16_f32 v145, v118, v119
  v_exp_f32 v122, v122
  v_exp_f32 v123, v123
  v_cvt_pk_bf16_f32 v146, v120, v121
  v_cvt_pk_bf16_f32 v147, v122, v123
  s_waitcnt vmcnt(7)
  v_mfma_f32_32x32x16_bf16 v[108:123], v[92:95], v[12:15], 0
  v_exp_f32 v124, v124
  v_exp_f32 v125, v125
  v_exp_f32 v126, v126
  v_exp_f32 v127, v127
  v_cvt_pk_bf16_f32 v148, v124, v125
  v_exp_f32 v128, v128
  v_mfma_f32_32x32x16_bf16 v[188:203], v[84:87], v[140:143], v[188:203]
  v_exp_f32 v129, v129
  v_cvt_pk_bf16_f32 v149, v126, v127
  v_exp_f32 v130, v130
  v_exp_f32 v131, v131
  v_cvt_pk_bf16_f32 v150, v128, v129
  v_exp_f32 v132, v132
  v_mfma_f32_32x32x16_bf16 v[108:123], v[96:99], v[16:19], v[108:123]
  v_exp_f32 v133, v133
  v_cvt_pk_bf16_f32 v151, v130, v131
  v_exp_f32 v134, v134
  v_exp_f32 v135, v135
  v_cvt_pk_bf16_f32 v152, v132, v133
  v_exp_f32 v136, v136
  v_mfma_f32_32x32x16_bf16 v[188:203], v[88:91], v[144:147], v[188:203]
  v_exp_f32 v137, v137
  v_cvt_pk_bf16_f32 v153, v134, v135
  v_exp_f32 v138, v138
  v_exp_f32 v139, v139
  v_cvt_pk_bf16_f32 v154, v136, v137
  v_cvt_pk_bf16_f32 v155, v138, v139
  v_mfma_f32_32x32x16_bf16 v[124:139], v[92:95], v[20:23], 0
  v_exp_f32 v108, v108
  v_exp_f32 v109, v109
  v_exp_f32 v110, v110
  v_exp_f32 v111, v111
  v_cvt_pk_bf16_f32 v140, v108, v109
  v_exp_f32 v112, v112
  v_mfma_f32_32x32x16_bf16 v[204:219], v[84:87], v[148:151], v[204:219]
  v_exp_f32 v113, v113
  v_cvt_pk_bf16_f32 v141, v110, v111
  v_exp_f32 v114, v114
  v_exp_f32 v115, v115
  v_cvt_pk_bf16_f32 v142, v112, v113
  v_exp_f32 v116, v116
  v_mfma_f32_32x32x16_bf16 v[124:139], v[96:99], v[24:27], v[124:139]
  v_exp_f32 v117, v117
  v_cvt_pk_bf16_f32 v143, v114, v115
  v_exp_f32 v118, v118
  v_exp_f32 v119, v119
  v_cvt_pk_bf16_f32 v144, v116, v117
  v_exp_f32 v120, v120
  v_mfma_f32_32x32x16_bf16 v[204:219], v[88:91], v[152:155], v[204:219]
  v_exp_f32 v121, v121
  v_cvt_pk_bf16_f32 v145, v118, v119
  v_exp_f32 v122, v122
  v_exp_f32 v123, v123
  v_cvt_pk_bf16_f32 v146, v120, v121
  v_cvt_pk_bf16_f32 v147, v122, v123
  v_mfma_f32_32x32x16_bf16 v[108:123], v[92:95], v[28:31], 0
  v_exp_f32 v124, v124
  v_exp_f32 v125, v125
  v_exp_f32 v126, v126
  v_exp_f32 v127, v127
  v_cvt_pk_bf16_f32 v148, v124, v125
  v_exp_f32 v128, v128
  s_waitcnt vmcnt(4)
  v_mfma_f32_32x32x16_bf16 v[156:171], v[100:103], v[140:143], v[156:171]
  v_exp_f32 v129, v129
  v_cvt_pk_bf16_f32 v149, v126, v127
  v_exp_f32 v130, v130
  v_exp_f32 v131, v131
  v_cvt_pk_bf16_f32 v150, v128, v129
  v_exp_f32 v132, v132
  v_mfma_f32_32x32x16_bf16 v[108:123], v[96:99], v[32:35], v[108:123]
  v_exp_f32 v133, v133
  v_cvt_pk_bf16_f32 v151, v130, v131
  v_exp_f32 v134, v134
  v_exp_f32 v135, v135
  v_cvt_pk_bf16_f32 v152, v132, v133
  v_exp_f32 v136, v136
  v_mfma_f32_32x32x16_bf16 v[156:171], v[104:107], v[144:147], v[156:171]
  v_exp_f32 v137, v137
  v_cvt_pk_bf16_f32 v153, v134, v135
  v_exp_f32 v138, v138
  v_exp_f32 v139, v139
  v_cvt_pk_bf16_f32 v154, v136, v137
  v_cvt_pk_bf16_f32 v155, v138, v139
  v_mfma_f32_32x32x16_bf16 v[124:139], v[92:95], v[36:39], 0
  v_exp_f32 v108, v108
  v_exp_f32 v109, v109
  v_exp_f32 v110, v110
  v_exp_f32 v111, v111
  v_cvt_pk_bf16_f32 v140, v108, v109
  v_exp_f32 v112, v112
  v_mfma_f32_32x32x16_bf16 v[172:187], v[100:103], v[148:151], v[172:187]
  v_exp_f32 v113, v113
  v_cvt_pk_bf16_f32 v141, v110, v111
  v_exp_f32 v114, v114
  v_exp_f32 v115, v115
  v_cvt_pk_bf16_f32 v142, v112, v113
  v_exp_f32 v116, v116
  v_mfma_f32_32x32x16_bf16 v[124:139], v[96:99], v[40:43], v[124:139]
  v_exp_f32 v117, v117
  v_cvt_pk_bf16_f32 v143, v114, v115
  v_exp_f32 v118, v118
  v_exp_f32 v119, v119
  v_cvt_pk_bf16_f32 v144, v116, v117
  v_exp_f32 v120, v120
  v_mfma_f32_32x32x16_bf16 v[172:187], v[104:107], v[152:155], v[172:187]
  v_exp_f32 v121, v121
  v_cvt_pk_bf16_f32 v145, v118, v119
  v_exp_f32 v122, v122
  v_exp_f32 v123, v123
  v_cvt_pk_bf16_f32 v146, v120, v121
  v_cvt_pk_bf16_f32 v147, v122, v123
  v_exp_f32 v124, v124
  v_exp_f32 v125, v125
  v_exp_f32 v126, v126
  v_exp_f32 v127, v127
  v_cvt_pk_bf16_f32 v148, v124, v125
  v_exp_f32 v128, v128
  v_mfma_f32_32x32x16_bf16 v[188:203], v[100:103], v[140:143], v[188:203]
  v_exp_f32 v129, v129
  v_cvt_pk_bf16_f32 v149, v126, v127
  v_exp_f32 v130, v130
  v_exp_f32 v131, v131
  v_cvt_pk_bf16_f32 v150, v128, v129
  v_exp_f32 v132, v132
  v_exp_f32 v133, v133
  v_cvt_pk_bf16_f32 v151, v130, v131
  v_exp_f32 v134, v134
  v_exp_f32 v135, v135
  v_cvt_pk_bf16_f32 v152, v132, v133
  v_exp_f32 v136, v136
  v_mfma_f32_32x32x16_bf16 v[188:203], v[104:107], v[144:147], v[188:203]
  v_exp_f32 v137, v137
  v_cvt_pk_bf16_f32 v153, v134, v135
  v_exp_f32 v138, v138
  v_exp_f32 v139, v139
  v_cvt_pk_bf16_f32 v154, v136, v137
  v_cvt_pk_bf16_f32 v155, v138, v139
  v_mfma_f32_32x32x16_bf16 v[204:219], v[100:103], v[148:151], v[204:219]
  s_nop 0
  v_mfma_f32_32x32x16_bf16 v[204:219], v[104:107], v[152:155], v[204:219]
  s_xor_b32 s25, s20, 1
  s_mul_i32 s25, s25, 12288
  s_add_u32 s25, s25, 114688
  v_add_u32 v5, s25, v3
  s_xor_b32 s25, s20, 2
  s_mul_i32 s25, s25, 12288
  s_add_u32 s25, s25, 118784
  v_add_u32 v6, s25, v3
  s_xor_b32 s25, s20, 3
  s_mul_i32 s25, s25, 12288
  s_add_u32 s25, s25, 122880
  v_add_u32 v7, s25, v3
  ds_write_b128 v5, v[172:175] offset:0
  ds_write_b128 v5, v[176:179] offset:1024
  ds_write_b128 v5, v[180:183] offset:2048
  ds_write_b128 v5, v[184:187] offset:3072
  ds_write_b128 v6, v[188:191] offset:0
  ds_write_b128 v6, v[192:195] offset:1024
  ds_write_b128 v6, v[196:199] offset:2048
  ds_write_b128 v6, v[200:203] offset:3072
  ds_write_b128 v7, v[204:207] offset:0
  ds_write_b128 v7, v[208:211] offset:1024
  ds_write_b128 v7, v[212:215] offset:2048
  ds_write_b128 v7, v[216:219] offset:3072
  s_mul_i32 s25, s20, 12288
  s_add_u32 s25, s25, 114688
  v_add_u32 v5, s25, v3
  s_waitcnt lgkmcnt(0)
  s_barrier
  ds_read_b128 v[172:175], v5 offset:0
  ds_read_b128 v[176:179], v5 offset:1024
  ds_read_b128 v[180:183], v5 offset:2048
  ds_read_b128 v[184:187], v5 offset:3072
  ds_read_b128 v[188:191], v5 offset:4096
  ds_read_b128 v[192:195], v5 offset:5120
  ds_read_b128 v[196:199], v5 offset:6144
  ds_read_b128 v[200:203], v5 offset:7168
  ds_read_b128 v[204:207], v5 offset:8192
  ds_read_b128 v[208:211], v5 offset:9216
  ds_read_b128 v[212:215], v5 offset:10240
  ds_read_b128 v[216:219], v5 offset:11264
  s_waitcnt lgkmcnt(8)
  v_pk_add_f32 v[156:157], v[156:157], v[172:173]
  v_pk_add_f32 v[158:159], v[158:159], v[174:175]
  v_pk_add_f32 v[160:161], v[160:161], v[176:177]
  v_pk_add_f32 v[162:163], v[162:163], v[178:179]
  v_pk_add_f32 v[164:165], v[164:165], v[180:181]
  v_pk_add_f32 v[166:167], v[166:167], v[182:183]
  v_pk_add_f32 v[168:169], v[168:169], v[184:185]
  v_pk_add_f32 v[170:171], v[170:171], v[186:187]
  s_waitcnt lgkmcnt(4)
  v_pk_add_f32 v[156:157], v[156:157], v[188:189]
  v_pk_add_f32 v[158:159], v[158:159], v[190:191]
  v_pk_add_f32 v[160:161], v[160:161], v[192:193]
  v_pk_add_f32 v[162:163], v[162:163], v[194:195]
  v_pk_add_f32 v[164:165], v[164:165], v[196:197]
  v_pk_add_f32 v[166:167], v[166:167], v[198:199]
  v_pk_add_f32 v[168:169], v[168:169], v[200:201]
  v_pk_add_f32 v[170:171], v[170:171], v[202:203]
  s_waitcnt lgkmcnt(0)
  v_pk_add_f32 v[156:157], v[156:157], v[204:205]
  v_pk_add_f32 v[158:159], v[158:159], v[206:207]
  v_pk_add_f32 v[160:161], v[160:161], v[208:209]
  v_pk_add_f32 v[162:163], v[162:163], v[210:211]
  v_pk_add_f32 v[164:165], v[164:165], v[212:213]
  v_pk_add_f32 v[166:167], v[166:167], v[214:215]
  v_pk_add_f32 v[168:169], v[168:169], v[216:217]
  v_pk_add_f32 v[170:171], v[170:171], v[218:219]
  v_mov_b32 v5, v168
  v_mov_b32 v6, v168
  s_nop 1
  v_permlane32_swap_b32 v5, v6
  v_mov_b32 v7, 0x5f800000
  v_mov_b32 v8, 0x1f800000
  v_cmp_lt_f32 vcc, v6, v7
  v_cmp_gt_f32 s[70:71], v6, v8
  s_nop 0
  s_and_b64 vcc, vcc, s[70:71]
  s_cmp_eq_u64 vcc, -1
  s_nop 11
  s_cbranch_scc0 L_att_slow
L_att_fin:
  v_rcp_f32 v7, v6
  s_nop 0
  v_mul_f32 v156, v156, v7
  v_mul_f32 v157, v157, v7
  v_mul_f32 v158, v158, v7
  v_mul_f32 v159, v159, v7
  v_mul_f32 v160, v160, v7
  v_mul_f32 v161, v161, v7
  v_mul_f32 v162, v162, v7
  v_mul_f32 v163, v163, v7
  v_mul_f32 v164, v164, v7
  v_mul_f32 v165, v165, v7
  v_mul_f32 v166, v166, v7
  v_mul_f32 v167, v167, v7
  v_mul_f32 v168, v168, v7
  v_mul_f32 v169, v169, v7
  v_mul_f32 v170, v170, v7
  v_mul_f32 v171, v171, v7
  v_cvt_pk_bf16_f32 v220, v156, v157
  v_cvt_pk_bf16_f32 v221, v158, v159
  v_cvt_pk_bf16_f32 v222, v160, v161
  v_cvt_pk_bf16_f32 v223, v162, v163
  v_cvt_pk_bf16_f32 v224, v164, v165
  v_cvt_pk_bf16_f32 v225, v166, v167
  v_cvt_pk_bf16_f32 v226, v168, v169
  v_cvt_pk_bf16_f32 v227, v170, v171
  v_mov_b32 v8, 0
  v_cndmask_b32 v226, v226, v8, s[50:51]
  v_cndmask_b32 v227, v227, v8, s[50:51]
  s_lshl_b32 s25, s69, 2
  s_add_u32 s25, s25, s20
  s_lshl_b32 s25, s25, 4
  s_add_u32 s25, s25, s68
  s_lshl_b32 s25, s25, 11
  buffer_store_dwordx4 v[220:223], v3, s[12:15], s25 offen sc1
  buffer_store_dwordx4 v[224:227], v3, s[12:15], s25 offen offset:1024 sc1
  s_waitcnt lgkmcnt(0)
  s_waitcnt vmcnt(0)
  s_barrier
  s_cmp_eq_u32 s20, 0
  s_cbranch_scc0 L_sig_17
  s_mul_i32 s25, s3, 80
  s_add_u32 s25, s25, 16
  s_add_u32 s25, s25, s69
  s_lshl_b32 s25, s25, 8
  v_mov_b32 v5, s25
  v_mov_b32 v6, 1
  s_mov_b64 exec, 1
  buffer_atomic_add v6, v5, s[52:55], 0 offen sc1
  s_mov_b64 exec, -1
L_sig_17:
  s_cmp_lt_u32 s22, 28
  s_cbranch_scc0 L_ncs_18
  s_cmp_eq_u32 s3, 0
  s_cbranch_scc0 L_ncs_18
  s_lshl_b32 s64, s21, 2
  s_and_b32 s25, s22, 3
  s_add_u32 s64, s64, s25
  s_lshr_b32 s61, s22, 2
  s_lshr_b32 s60, s64, 1
  s_lshl_b32 s62, s64, 1
  s_lshr_b32 s25, s20, 1
  s_add_u32 s62, s62, s25
  s_lshl_b32 s63, s61, 1
  s_and_b32 s25, s20, 1
  s_add_u32 s63, s63, s25
  v_lshrrev_b32 v5, 3, v1
  v_and_b32 v6, 7, v1
  v_bfe_u32 v7, v1, 4, 1
  v_lshlrev_b32 v7, 2, v7
  v_xor_b32 v6, v6, v7
  v_mul_u32_u24 v40, 896, v5
  v_lshlrev_b32 v6, 4, v6
  v_add_u32 v40, v40, v6
  s_lshl_b32 s25, s61, 7
  v_add_u32 v40, s25, v40
  s_mul_i32 s74, s20, 12288
  s_add_u32 s74, s74, 114688
  v_bfe_u32 v5, v1, 2, 2
  v_lshlrev_b32 v6, 2, v2
  v_add_u32 v6, v6, v5
  v_lshlrev_b32 v6, 7, v6
  v_and_b32 v7, 3, v1
  v_lshlrev_b32 v7, 3, v7
  v_add_u32 v6, v6, v7
  v_bfe_u32 v7, v1, 4, 1
  v_lshlrev_b32 v7, 5, v7
  v_add_u32 v6, v6, v7
  v_bfe_u32 v7, v1, 3, 1
  s_and_b32 s25, s20, 1
  v_xor_b32 v7, s25, v7
  v_lshlrev_b32 v7, 6, v7
  v_add_u32 v6, s74, v6
  v_add_u32 v41, v6, v7
  v_xor_b32 v7, 64, v7
  v_add_u32 v42, v6, v7
  s_add_u32 s84, s40, 0
  s_addc_u32 s85, s41, 0
  s_and_b32 s85, s85, 0xffff
  s_mov_b32 s86, 1605632
  s_mov_b32 s87, 0x20000
  s_mul_i32 s26, s20, 401408
  s_add_u32 m0, s74, 0
  s_add_u32 s27, s26, 86016
  buffer_load_dwordx4 v40, s[84:87], s27 offen lds
  s_add_u32 m0, s74, 1024
  s_add_u32 s27, s26, 93184
  buffer_load_dwordx4 v40, s[84:87], s27 offen lds
  s_add_u32 m0, s74, 2048
  s_add_u32 s27, s26, 100352
  buffer_load_dwordx4 v40, s[84:87], s27 offen lds
  s_add_u32 m0, s74, 3072
  s_add_u32 s27, s26, 107520
  buffer_load_dwordx4 v40, s[84:87], s27 offen lds
  s_add_u32 m0, s74, 4096
  s_add_u32 s27, s26, 114688
  buffer_load_dwordx4 v40, s[84:87], s27 offen lds
  s_add_u32 m0, s74, 5120
  s_add_u32 s27, s26, 121856
  buffer_load_dwordx4 v40, s[84:87], s27 offen lds
  s_add_u32 m0, s74, 6144
  s_add_u32 s27, s26, 129024
  buffer_load_dwordx4 v40, s[84:87], s27 offen lds
  s_add_u32 m0, s74, 7168
  s_add_u32 s27, s26, 136192
  buffer_load_dwordx4 v40, s[84:87], s27 offen lds
  s_add_u32 m0, s74, 8192
  s_add_u32 s27, s26, 143360
  buffer_load_dwordx4 v40, s[84:87], s27 offen lds
  s_add_u32 m0, s74, 9216
  s_add_u32 s27, s26, 150528
  buffer_load_dwordx4 v40, s[84:87], s27 offen lds
  s_add_u32 m0, s74, 10240
  s_add_u32 s27, s26, 157696
  buffer_load_dwordx4 v40, s[84:87], s27 offen lds
  s_add_u32 m0, s74, 11264
  s_add_u32 s27, s26, 164864
  buffer_load_dwordx4 v40, s[84:87], s27 offen lds
  v_bfe_u32 v5, v1, 2, 2
  v_lshlrev_b32 v6, 2, v2
  v_add_u32 v6, v6, v5
  v_lshlrev_b32 v6, 8, v6
  v_and_b32 v7, 3, v1
  v_lshlrev_b32 v7, 3, v7
  v_add_u32 v6, v6, v7
  v_bfe_u32 v7, v1, 4, 1
  v_lshlrev_b32 v7, 5, v7
  v_add_u32 v6, v6, v7
  v_xor_b32 v7, 0, v5
  v_lshlrev_b32 v7, 6, v7
  v_add_u32 v20, v6, v7
  v_xor_b32 v7, 1, v5
  v_lshlrev_b32 v7, 6, v7
  v_add_u32 v21, v6, v7
  v_xor_b32 v7, 2, v5
  v_lshlrev_b32 v7, 6, v7
  v_add_u32 v22, v6, v7
  v_xor_b32 v7, 3, v5
  v_lshlrev_b32 v7, 6, v7
  v_add_u32 v23, v6, v7
  v_xor_b32 v7, s20, v5
  v_lshlrev_b32 v7, 6, v7
  v_add_u32 v8, v6, v7
  v_mov_b32 v48, v8
  v_mov_b32 v44, 0
  v_mov_b32 v45, 0
  v_mov_b32 v46, 0
  v_mov_b32 v47, 0
  s_mov_b32 s67, 0
L_cs_19:
  ds_read_b64_tr_b16 v[52:53], v48 offset:0
  ds_read_b64_tr_b16 v[54:55], v48 offset:2048
  ds_read_b64_tr_b16 v[56:57], v48 offset:4096
  ds_read_b64_tr_b16 v[58:59], v48 offset:6144
  ds_read_b64_tr_b16 v[60:61], v48 offset:8192
  ds_read_b64_tr_b16 v[62:63], v48 offset:10240
  ds_read_b64_tr_b16 v[64:65], v48 offset:12288
  ds_read_b64_tr_b16 v[66:67], v48 offset:14336
  v_add_u32 v48, 16384, v48
  s_waitcnt lgkmcnt(6)
  v_dot2c_f32_bf16 v44, s56, v52
  v_dot2c_f32_bf16 v45, s56, v53
  v_dot2c_f32_bf16 v46, s56, v54
  v_dot2c_f32_bf16 v47, s56, v55
  s_waitcnt lgkmcnt(4)
  v_dot2c_f32_bf16 v44, s56, v56
  v_dot2c_f32_bf16 v45, s56, v57
  v_dot2c_f32_bf16 v46, s56, v58
  v_dot2c_f32_bf16 v47, s56, v59
  s_waitcnt lgkmcnt(2)
  v_dot2c_f32_bf16 v44, s56, v60
  v_dot2c_f32_bf16 v45, s56, v61
  v_dot2c_f32_bf16 v46, s56, v62
  v_dot2c_f32_bf16 v47, s56, v63
  s_waitcnt lgkmcnt(0)
  v_dot2c_f32_bf16 v44, s56, v64
  v_dot2c_f32_bf16 v45, s56, v65
  v_dot2c_f32_bf16 v46, s56, v66
  v_dot2c_f32_bf16 v47, s56, v67
  s_add_u32 s67, s67, 1
  s_cmp_lt_u32 s67, 7
  s_cbranch_scc1 L_cs_19
  v_add_f32 v44, v44, v45
  v_add_f32 v46, v46, v47
  v_add_f32 v44, v44, v46
  v_mov_b32 v45, v44
  s_nop 1
  v_permlane32_swap_b32 v44, v45
  v_add_f32 v44, v44, v45
  v_mov_b32 v11, v44
  s_waitcnt vmcnt(10)
  ds_read_b64_tr_b16 a[112:113], v41 offset:0
  ds_read_b64_tr_b16 a[114:115], v41 offset:1024
  ds_read_b64_tr_b16 a[116:117], v42 offset:0
  ds_read_b64_tr_b16 a[118:119], v42 offset:1024
  s_waitcnt vmcnt(8)
  ds_read_b64_tr_b16 a[120:121], v41 offset:2048
  ds_read_b64_tr_b16 a[122:123], v41 offset:3072
  ds_read_b64_tr_b16 a[124:125], v42 offset:2048
  ds_read_b64_tr_b16 a[126:127], v42 offset:3072
  s_waitcnt vmcnt(6)
  ds_read_b64_tr_b16 a[128:129], v41 offset:4096
  ds_read_b64_tr_b16 a[130:131], v41 offset:5120
  ds_read_b64_tr_b16 a[132:133], v42 offset:4096
  ds_read_b64_tr_b16 a[134:135], v42 offset:5120
  s_waitcnt vmcnt(4)
  ds_read_b64_tr_b16 a[136:137], v41 offset:6144
  ds_read_b64_tr_b16 a[138:139], v41 offset:7168
  ds_read_b64_tr_b16 a[140:141], v42 offset:6144
  ds_read_b64_tr_b16 a[142:143], v42 offset:7168
  s_waitcnt vmcnt(2)
  ds_read_b64_tr_b16 a[144:145], v41 offset:8192
  ds_read_b64_tr_b16 a[146:147], v41 offset:9216
  ds_read_b64_tr_b16 a[148:149], v42 offset:8192
  ds_read_b64_tr_b16 a[150:151], v42 offset:9216
  s_waitcnt vmcnt(0)
  ds_read_b64_tr_b16 a[152:153], v41 offset:10240
  ds_read_b64_tr_b16 a[154:155], v41 offset:11264
  ds_read_b64_tr_b16 a[156:157], v42 offset:10240
  ds_read_b64_tr_b16 a[158:159], v42 offset:11264
  s_waitcnt lgkmcnt(0)
L_ncs_18:
  s_lshl_b32 s64, s21, 2
  s_and_b32 s25, s22, 3
  s_add_u32 s64, s64, s25
  s_lshr_b32 s61, s22, 2
  s_lshr_b32 s60, s64, 1
  s_lshl_b32 s62, s64, 1
  s_lshr_b32 s25, s20, 1
  s_add_u32 s62, s62, s25
  s_lshl_b32 s63, s61, 1
  s_and_b32 s25, s20, 1
  s_add_u32 s63, s63, s25
  s_cmp_lt_u32 s61, 7
  s_cbranch_scc0 L_wo_skip
  s_add_u32 s25, s72, 6291456
  s_add_u32 s4, s48, s25
  s_addc_u32 s5, s49, 0
  s_and_b32 s5, s5, 0xffff
  s_mov_b32 s6, 2097152
  s_mov_b32 s7, 0x20000
  s_lshl_b32 s74, s62, 15
  s_xor_b32 s75, s62, 1
  s_lshl_b32 s75, s75, 15
  s_lshl_b32 s25, s20, 13
  s_add_u32 s74, s74, s25
  s_add_u32 s75, s75, s25
  s_sub_u32 s26, 20971520, s72
  s_mul_i32 s27, s62, 28672
  s_add_u32 s27, s27, s26
  s_add_u32 s27, s27, 17825792
  s_add_u32 s8, s48, s27
  s_addc_u32 s9, s49, 0
  s_and_b32 s9, s9, 0xffff
  s_mov_b32 s10, 28672
  s_mov_b32 s11, 0x20000
  s_cmp_eq_u32 s20, 0
  s_cbranch_scc0 L_wt_20
  s_mul_i32 s25, s3, 80
  s_add_u32 s25, s25, 16
  s_add_u32 s25, s25, s60
  s_lshl_b32 s25, s25, 8
  v_mov_b32 v5, s25
  s_mov_b32 s26, 0
L_sp_21:
  buffer_load_dword v6, v5, s[52:55], 0 offen sc1
  s_waitcnt vmcnt(0)
  v_readfirstlane_b32 s25, v6
  s_add_u32 s26, s26, 1
  s_cmp_gt_u32 s26, 20000
  s_cbranch_scc1 L_wt_20x
  s_cmp_lt_u32 s25, 16
  s_cbranch_scc1 L_sp_21
L_wt_20x:
L_wt_20:
  s_barrier
  buffer_load_dwordx4 v[20:23], v3, s[4:7], s74 offen offset:0 sc1
  buffer_load_dwordx4 v[24:27], v3, s[4:7], s75 offen offset:0 sc1
  buffer_load_dwordx4 v[28:31], v3, s[4:7], s74 offen offset:1024 sc1
  buffer_load_dwordx4 v[32:35], v3, s[4:7], s75 offen offset:1024 sc1
  buffer_load_dwordx4 v[36:39], v3, s[4:7], s74 offen offset:2048 sc1
  buffer_load_dwordx4 v[40:43], v3, s[4:7], s75 offen offset:2048 sc1
  buffer_load_dwordx4 v[44:47], v3, s[4:7], s74 offen offset:3072 sc1
  buffer_load_dwordx4 v[48:51], v3, s[4:7], s75 offen offset:3072 sc1
  s_add_u32 s74, s74, 4096
  s_add_u32 s75, s75, 4096
  buffer_load_dwordx4 v[52:55], v3, s[4:7], s74 offen offset:0 sc1
  buffer_load_dwordx4 v[56:59], v3, s[4:7], s75 offen offset:0 sc1
  buffer_load_dwordx4 v[60:63], v3, s[4:7], s74 offen offset:1024 sc1
  buffer_load_dwordx4 v[64:67], v3, s[4:7], s75 offen offset:1024 sc1
  buffer_load_dwordx4 v[68:71], v3, s[4:7], s74 offen offset:2048 sc1
  buffer_load_dwordx4 v[72:75], v3, s[4:7], s75 offen offset:2048 sc1
  buffer_load_dwordx4 v[76:79], v3, s[4:7], s74 offen offset:3072 sc1
  buffer_load_dwordx4 v[80:83], v3, s[4:7], s75 offen offset:3072 sc1
  s_lshl_b32 s25, s63, 11
  buffer_load_dwordx4 v[12:15], v3, s[8:11], s25 offen sc1
  buffer_load_dwordx4 v[16:19], v3, s[8:11], s25 offen offset:1024 sc1
  s_waitcnt vmcnt(16)
  v_mfma_f32_32x32x16_bf16 v[84:99], a[0:3], v[20:23], 0
  v_mfma_f32_32x32x16_bf16 v[100:115], a[4:7], v[20:23], 0
  v_mfma_f32_32x32x16_bf16 v[116:131], a[0:3], v[24:27], 0
  v_mfma_f32_32x32x16_bf16 v[132:147], a[4:7], v[24:27], 0
  s_waitcnt vmcnt(14)
  v_mfma_f32_32x32x16_bf16 v[84:99], a[8:11], v[28:31], v[84:99]
  v_mfma_f32_32x32x16_bf16 v[100:115], a[12:15], v[28:31], v[100:115]
  v_mfma_f32_32x32x16_bf16 v[116:131], a[8:11], v[32:35], v[116:131]
  v_mfma_f32_32x32x16_bf16 v[132:147], a[12:15], v[32:35], v[132:147]
  s_waitcnt vmcnt(12)
  v_mfma_f32_32x32x16_bf16 v[84:99], a[16:19], v[36:39], v[84:99]
  v_mfma_f32_32x32x16_bf16 v[100:115], a[20:23], v[36:39], v[100:115]
  v_mfma_f32_32x32x16_bf16 v[116:131], a[16:19], v[40:43], v[116:131]
  v_mfma_f32_32x32x16_bf16 v[132:147], a[20:23], v[40:43], v[132:147]
  s_waitcnt vmcnt(10)
  v_mfma_f32_32x32x16_bf16 v[84:99], a[24:27], v[44:47], v[84:99]
  v_mfma_f32_32x32x16_bf16 v[100:115], a[28:31], v[44:47], v[100:115]
  v_mfma_f32_32x32x16_bf16 v[116:131], a[24:27], v[48:51], v[116:131]
  v_mfma_f32_32x32x16_bf16 v[132:147], a[28:31], v[48:51], v[132:147]
  s_waitcnt vmcnt(8)
  v_mfma_f32_32x32x16_bf16 v[84:99], a[32:35], v[52:55], v[84:99]
  v_mfma_f32_32x32x16_bf16 v[100:115], a[36:39], v[52:55], v[100:115]
  v_mfma_f32_32x32x16_bf16 v[116:131], a[32:35], v[56:59], v[116:131]
  v_mfma_f32_32x32x16_bf16 v[132:147], a[36:39], v[56:59], v[132:147]
  s_waitcnt vmcnt(6)
  v_mfma_f32_32x32x16_bf16 v[84:99], a[40:43], v[60:63], v[84:99]
  v_mfma_f32_32x32x16_bf16 v[100:115], a[44:47], v[60:63], v[100:115]
  v_mfma_f32_32x32x16_bf16 v[116:131], a[40:43], v[64:67], v[116:131]
  v_mfma_f32_32x32x16_bf16 v[132:147], a[44:47], v[64:67], v[132:147]
  s_waitcnt vmcnt(4)
  v_mfma_f32_32x32x16_bf16 v[84:99], a[48:51], v[68:71], v[84:99]
  v_mfma_f32_32x32x16_bf16 v[100:115], a[52:55], v[68:71], v[100:115]
  v_mfma_f32_32x32x16_bf16 v[116:131], a[48:51], v[72:75], v[116:131]
  v_mfma_f32_32x32x16_bf16 v[132:147], a[52:55], v[72:75], v[132:147]
  s_waitcnt vmcnt(2)
  v_mfma_f32_32x32x16_bf16 v[84:99], a[56:59], v[76:79], v[84:99]
  v_mfma_f32_32x32x16_bf16 v[100:115], a[60:63], v[76:79], v[100:115]
  v_mfma_f32_32x32x16_bf16 v[116:131], a[56:59], v[80:83], v[116:131]
  v_mfma_f32_32x32x16_bf16 v[132:147], a[60:63], v[80:83], v[132:147]
  s_xor_b32 s25, s20, 1
  s_mul_i32 s25, s25, 12288
  s_add_u32 s25, s25, 114688
  v_add_u32 v5, s25, v3
  s_xor_b32 s25, s20, 2
  s_mul_i32 s25, s25, 12288
  s_add_u32 s25, s25, 118784
  v_add_u32 v6, s25, v3
  s_xor_b32 s25, s20, 3
  s_mul_i32 s25, s25, 12288
  s_add_u32 s25, s25, 122880
  v_add_u32 v7, s25, v3
  ds_write_b128 v5, v[100:103] offset:0
  ds_write_b128 v5, v[104:107] offset:1024
  ds_write_b128 v5, v[108:111] offset:2048
  ds_write_b128 v5, v[112:115] offset:3072
  ds_write_b128 v6, v[116:119] offset:0
  ds_write_b128 v6, v[120:123] offset:1024
  ds_write_b128 v6, v[124:127] offset:2048
  ds_write_b128 v6, v[128:131] offset:3072
  ds_write_b128 v7, v[132:135] offset:0
  ds_write_b128 v7, v[136:139] offset:1024
  ds_write_b128 v7, v[140:143] offset:2048
  ds_write_b128 v7, v[144:147] offset:3072
  s_waitcnt vmcnt(0)
  v_lshlrev_b32 v5, 16, v12
  v_and_b32 v6, 0xffff0000, v12
  v_add_f32 v84, v84, v5
  v_add_f32 v85, v85, v6
  v_lshlrev_b32 v7, 16, v13
  v_and_b32 v8, 0xffff0000, v13
  v_add_f32 v86, v86, v7
  v_add_f32 v87, v87, v8
  v_lshlrev_b32 v5, 16, v14
  v_and_b32 v6, 0xffff0000, v14
  v_add_f32 v88, v88, v5
  v_add_f32 v89, v89, v6
  v_lshlrev_b32 v7, 16, v15
  v_and_b32 v8, 0xffff0000, v15
  v_add_f32 v90, v90, v7
  v_add_f32 v91, v91, v8
  v_lshlrev_b32 v5, 16, v16
  v_and_b32 v6, 0xffff0000, v16
  v_add_f32 v92, v92, v5
  v_add_f32 v93, v93, v6
  v_lshlrev_b32 v7, 16, v17
  v_and_b32 v8, 0xffff0000, v17
  v_add_f32 v94, v94, v7
  v_add_f32 v95, v95, v8
  v_lshlrev_b32 v5, 16, v18
  v_and_b32 v6, 0xffff0000, v18
  v_add_f32 v96, v96, v5
  v_add_f32 v97, v97, v6
  v_lshlrev_b32 v7, 16, v19
  v_and_b32 v8, 0xffff0000, v19
  v_add_f32 v98, v98, v7
  v_add_f32 v99, v99, v8
  s_mul_i32 s25, s20, 12288
  s_add_u32 s25, s25, 114688
  v_add_u32 v5, s25, v3
  s_waitcnt lgkmcnt(0)
  s_barrier
  ds_read_b128 v[100:103], v5 offset:0
  ds_read_b128 v[104:107], v5 offset:1024
  ds_read_b128 v[108:111], v5 offset:2048
  ds_read_b128 v[112:115], v5 offset:3072
  ds_read_b128 v[116:119], v5 offset:4096
  ds_read_b128 v[120:123], v5 offset:5120
  ds_read_b128 v[124:127], v5 offset:6144
  ds_read_b128 v[128:131], v5 offset:7168
  ds_read_b128 v[132:135], v5 offset:8192
  ds_read_b128 v[136:139], v5 offset:9216
  ds_read_b128 v[140:143], v5 offset:10240
  ds_read_b128 v[144:147], v5 offset:11264
  s_waitcnt lgkmcnt(8)
  v_pk_add_f32 v[84:85], v[84:85], v[100:101]
  v_pk_add_f32 v[86:87], v[86:87], v[102:103]
  v_pk_add_f32 v[88:89], v[88:89], v[104:105]
  v_pk_add_f32 v[90:91], v[90:91], v[106:107]
  v_pk_add_f32 v[92:93], v[92:93], v[108:109]
  v_pk_add_f32 v[94:95], v[94:95], v[110:111]
  v_pk_add_f32 v[96:97], v[96:97], v[112:113]
  v_pk_add_f32 v[98:99], v[98:99], v[114:115]
  s_waitcnt lgkmcnt(4)
  v_pk_add_f32 v[84:85], v[84:85], v[116:117]
  v_pk_add_f32 v[86:87], v[86:87], v[118:119]
  v_pk_add_f32 v[88:89], v[88:89], v[120:121]
  v_pk_add_f32 v[90:91], v[90:91], v[122:123]
  v_pk_add_f32 v[92:93], v[92:93], v[124:125]
  v_pk_add_f32 v[94:95], v[94:95], v[126:127]
  v_pk_add_f32 v[96:97], v[96:97], v[128:129]
  v_pk_add_f32 v[98:99], v[98:99], v[130:131]
  s_waitcnt lgkmcnt(0)
  v_pk_add_f32 v[84:85], v[84:85], v[132:133]
  v_pk_add_f32 v[86:87], v[86:87], v[134:135]
  v_pk_add_f32 v[88:89], v[88:89], v[136:137]
  v_pk_add_f32 v[90:91], v[90:91], v[138:139]
  v_pk_add_f32 v[92:93], v[92:93], v[140:141]
  v_pk_add_f32 v[94:95], v[94:95], v[142:143]
  v_pk_add_f32 v[96:97], v[96:97], v[144:145]
  v_pk_add_f32 v[98:99], v[98:99], v[146:147]
  s_add_u32 s74, s72, 8388608
  s_add_u32 s75, s72, 19922944
  v_cvt_pk_bf16_f32 v148, v84, v85
  v_cvt_pk_bf16_f32 v149, v86, v87
  v_cvt_pk_bf16_f32 v150, v88, v89
  v_cvt_pk_bf16_f32 v151, v90, v91
  v_cvt_pk_bf16_f32 v152, v92, v93
  v_cvt_pk_bf16_f32 v153, v94, v95
  v_cvt_pk_bf16_f32 v154, v96, v97
  v_cvt_pk_bf16_f32 v155, v98, v99
  s_mul_i32 s25, s62, 28672
  s_add_u32 s25, s25, s74
  s_add_u32 s12, s48, s25
  s_addc_u32 s13, s49, 0
  s_and_b32 s13, s13, 0xffff
  s_mov_b32 s14, 28672
  s_mov_b32 s15, 0x20000
  s_lshl_b32 s25, s63, 11
  buffer_store_dwordx4 v[148:151], v3, s[12:15], s25 offen sc1
  buffer_store_dwordx4 v[152:155], v3, s[12:15], s25 offen offset:1024 sc1
  v_pk_add_f32 v[100:101], v[84:85], v[86:87]
  v_pk_mul_f32 v[102:103], v[84:85], v[84:85]
  v_pk_fma_f32 v[102:103], v[86:87], v[86:87], v[102:103]
  v_pk_add_f32 v[100:101], v[100:101], v[88:89]
  v_pk_fma_f32 v[102:103], v[88:89], v[88:89], v[102:103]
  v_pk_add_f32 v[100:101], v[100:101], v[90:91]
  v_pk_fma_f32 v[102:103], v[90:91], v[90:91], v[102:103]
  v_pk_add_f32 v[100:101], v[100:101], v[92:93]
  v_pk_fma_f32 v[102:103], v[92:93], v[92:93], v[102:103]
  v_pk_add_f32 v[100:101], v[100:101], v[94:95]
  v_pk_fma_f32 v[102:103], v[94:95], v[94:95], v[102:103]
  v_pk_add_f32 v[100:101], v[100:101], v[96:97]
  v_pk_fma_f32 v[102:103], v[96:97], v[96:97], v[102:103]
  v_pk_add_f32 v[100:101], v[100:101], v[98:99]
  v_pk_fma_f32 v[102:103], v[98:99], v[98:99], v[102:103]
  v_add_f32 v156, v100, v101
  v_add_f32 v157, v102, v103
  v_mov_b32 v5, v156
  s_nop 1
  v_permlane32_swap_b32 v156, v5
  v_add_f32 v156, v156, v5
  v_mov_b32 v6, v157
  s_nop 1
  v_permlane32_swap_b32 v157, v6
  v_add_f32 v157, v157, v6
  s_mul_i32 s25, s62, 14
  s_add_u32 s25, s25, s63
  s_lshl_b32 s25, s25, 8
  s_add_u32 s25, s25, s75
  s_add_u32 s16, s48, s25
  s_addc_u32 s17, s49, 0
  s_and_b32 s17, s17, 0xffff
  s_mov_b32 s18, 256
  s_mov_b32 s19, 0x20000
  v_lshlrev_b32 v5, 3, v4
  buffer_store_dwordx2 v[156:157], v5, s[16:19], 0 offen sc1
  s_waitcnt vmcnt(0)
  s_barrier
  s_cmp_eq_u32 s20, 0
  s_cbranch_scc0 L_sig_22
  s_mul_i32 s25, s3, 80
  s_add_u32 s25, s25, 32
  s_add_u32 s25, s25, s60
  s_lshl_b32 s25, s25, 8
  v_mov_b32 v5, s25
  v_mov_b32 v6, 1
  s_mov_b64 exec, 1
  buffer_atomic_add v6, v5, s[52:55], 0 offen
  s_mov_b64 exec, -1
L_sig_22:
  s_cmp_eq_u32 s3, 0
  s_cbranch_scc0 L_wo_skip
  v_lshrrev_b32 v5, 3, v1
  v_and_b32 v6, 7, v1
  v_bfe_u32 v7, v1, 4, 1
  v_lshlrev_b32 v7, 2, v7
  v_xor_b32 v6, v6, v7
  v_mul_u32_u24 v40, 896, v5
  v_lshlrev_b32 v6, 4, v6
  v_add_u32 v40, v40, v6
  s_lshl_b32 s25, s61, 7
  v_add_u32 v40, s25, v40
  s_mul_i32 s74, s20, 11264
  s_add_u32 s74, s74, 114688
  v_bfe_u32 v5, v1, 2, 2
  v_lshlrev_b32 v6, 2, v2
  v_add_u32 v6, v6, v5
  v_lshlrev_b32 v6, 7, v6
  v_and_b32 v7, 3, v1
  v_lshlrev_b32 v7, 3, v7
  v_add_u32 v6, v6, v7
  v_bfe_u32 v7, v1, 4, 1
  v_lshlrev_b32 v7, 5, v7
  v_add_u32 v6, v6, v7
  v_bfe_u32 v7, v1, 3, 1
  s_and_b32 s25, s20, 1
  v_xor_b32 v7, s25, v7
  v_lshlrev_b32 v7, 6, v7
  v_add_u32 v6, s74, v6
  v_add_u32 v41, v6, v7
  v_xor_b32 v7, 64, v7
  v_add_u32 v42, v6, v7
  s_add_u32 s84, s40, 0
  s_addc_u32 s85, s41, 0
  s_and_b32 s85, s85, 0xffff
  s_mov_b32 s86, 1605632
  s_mov_b32 s87, 0x20000
  s_mul_i32 s26, s20, 401408
  s_add_u32 m0, s74, 0
  s_add_u32 s27, s26, 172032
  buffer_load_dwordx4 v40, s[84:87], s27 offen lds
  s_add_u32 m0, s74, 1024
  s_add_u32 s27, s26, 179200
  buffer_load_dwordx4 v40, s[84:87], s27 offen lds
  s_add_u32 m0, s74, 2048
  s_add_u32 s27, s26, 186368
  buffer_load_dwordx4 v40, s[84:87], s27 offen lds
  s_add_u32 m0, s74, 3072
  s_add_u32 s27, s26, 193536
  buffer_load_dwordx4 v40, s[84:87], s27 offen lds
  s_add_u32 m0, s74, 4096
  s_add_u32 s27, s26, 200704
  buffer_load_dwordx4 v40, s[84:87], s27 offen lds
  s_add_u32 m0, s74, 5120
  s_add_u32 s27, s26, 207872
  buffer_load_dwordx4 v40, s[84:87], s27 offen lds
  s_add_u32 m0, s74, 6144
  s_add_u32 s27, s26, 215040
  buffer_load_dwordx4 v40, s[84:87], s27 offen lds
  s_add_u32 m0, s74, 7168
  s_add_u32 s27, s26, 222208
  buffer_load_dwordx4 v40, s[84:87], s27 offen lds
  s_add_u32 m0, s74, 8192
  s_add_u32 s27, s26, 229376
  buffer_load_dwordx4 v40, s[84:87], s27 offen lds
  s_add_u32 m0, s74, 9216
  s_add_u32 s27, s26, 236544
  buffer_load_dwordx4 v40, s[84:87], s27 offen lds
  s_waitcnt vmcnt(8)
  ds_read_b64_tr_b16 a[160:161], v41 offset:0
  ds_read_b64_tr_b16 a[162:163], v41 offset:1024
  ds_read_b64_tr_b16 a[164:165], v42 offset:0
  ds_read_b64_tr_b16 a[166:167], v42 offset:1024
  s_waitcnt vmcnt(6)
  ds_read_b64_tr_b16 a[168:169], v41 offset:2048
  ds_read_b64_tr_b16 a[170:171], v41 offset:3072
  ds_read_b64_tr_b16 a[172:173], v42 offset:2048
  ds_read_b64_tr_b16 a[174:175], v42 offset:3072
  s_waitcnt vmcnt(4)
  ds_read_b64_tr_b16 a[176:177], v41 offset:4096
  ds_read_b64_tr_b16 a[178:179], v41 offset:5120
  ds_read_b64_tr_b16 a[180:181], v42 offset:4096
  ds_read_b64_tr_b16 a[182:183], v42 offset:5120
  s_waitcnt vmcnt(2)
  ds_read_b64_tr_b16 a[184:185], v41 offset:6144
  ds_read_b64_tr_b16 a[186:187], v41 offset:7168
  ds_read_b64_tr_b16 a[188:189], v42 offset:6144
  ds_read_b64_tr_b16 a[190:191], v42 offset:7168
  s_waitcnt vmcnt(0)
  ds_read_b64_tr_b16 a[192:193], v41 offset:8192
  ds_read_b64_tr_b16 a[194:195], v41 offset:9216
  ds_read_b64_tr_b16 a[196:197], v42 offset:8192
  ds_read_b64_tr_b16 a[198:199], v42 offset:9216
  s_waitcnt lgkmcnt(0)
L_wo_skip:
  s_cmp_lt_u32 s22, 28
  s_cbranch_scc0 L_ffn1_skip
  s_lshl_b32 s60, s21, 1
  s_and_b32 s25, s22, 1
  s_add_u32 s60, s60, s25
  s_lshr_b32 s61, s22, 1
  s_add_u32 s8, s38, 0
  s_addc_u32 s9, s39, 0
  s_and_b32 s9, s9, 0xffff
  s_mov_b32 s10, 3584
  s_mov_b32 s11, 0x20000
  s_lshl_b32 s26, s61, 7
  v_add_lshl_u32 v6, s26, v4, 1
  buffer_load_ushort v17, v6, s[8:11], 0 offen offset:0
  buffer_load_ushort v18, v6, s[8:11], 0 offen offset:64
  buffer_load_ushort v19, v6, s[8:11], 0 offen offset:128
  buffer_load_ushort v20, v6, s[8:11], 0 offen offset:192
  s_lshl_b32 s62, s60, 2
  s_add_u32 s62, s62, s20
  s_mul_i32 s27, s62, 28672
  s_add_u32 s27, s27, s72
  s_add_u32 s27, s27, 8388608
  s_add_u32 s4, s48, s27
  s_addc_u32 s5, s49, 0
  s_and_b32 s5, s5, 0xffff
  s_mov_b32 s6, 28672
  s_mov_b32 s7, 0x20000
  s_mul_i32 s27, s62, 3584
  s_add_u32 s27, s27, s72
  s_add_u32 s27, s27, 19922944
  s_add_u32 s8, s48, s27
  s_addc_u32 s9, s49, 0
  s_and_b32 s9, s9, 0xffff
  s_mov_b32 s10, 3584
  s_mov_b32 s11, 0x20000
  v_mov_b32 v12, v3
  s_mov_b32 s75, 1024
  s_mov_b32 s74, 0
  v_bfe_u32 v5, v1, 2, 2
  v_lshlrev_b32 v6, 2, v2
  v_add_u32 v6, v6, v5
  v_lshlrev_b32 v6, 8, v6
  v_and_b32 v7, 3, v1
  v_lshlrev_b32 v7, 3, v7
  v_add_u32 v6, v6, v7
  v_bfe_u32 v7, v1, 4, 1
  v_lshlrev_b32 v7, 5, v7
  v_add_u32 v6, v6, v7
  v_xor_b32 v7, 0, v5
  v_lshlrev_b32 v7, 6, v7
  v_add_u32 v13, v6, v7
  v_xor_b32 v7, 1, v5
  v_lshlrev_b32 v7, 6, v7
  v_add_u32 v14, v6, v7
  v_xor_b32 v7, 2, v5
  v_lshlrev_b32 v7, 6, v7
  v_add_u32 v15, v6, v7
  v_xor_b32 v7, 3, v5
  v_lshlrev_b32 v7, 6, v7
  v_add_u32 v16, v6, v7
  v_xor_b32 v7, s20, v5
  v_lshlrev_b32 v7, 6, v7
  v_add_u32 v8, v6, v7
  s_lshl_b32 s25, s20, 7
  s_add_u32 s25, s25, 162816
  v_lshl_add_u32 v5, v4, 2, s25
  ds_write_b32 v5, v11
  s_waitcnt lgkmcnt(0)
  s_cmp_eq_u32 s20, 0
  s_cbranch_scc0 L_wt_23
  s_mul_i32 s25, s3, 80
  s_add_u32 s25, s25, 32
  s_add_u32 s25, s25, s60
  s_lshl_b32 s25, s25, 8
  v_mov_b32 v5, s25
  s_mov_b32 s26, 0
  s_mov_b64 exec, 1
L_sp_24:
  v_mov_b32 v6, 0
  buffer_atomic_add v6, v5, s[52:55], 0 offen sc0
  s_waitcnt vmcnt(0)
  v_readfirstlane_b32 s25, v6
  s_add_u32 s26, s26, 1
  s_cmp_gt_u32 s26, 20000
  s_cbranch_scc1 L_wt_23x
  s_cmp_lt_u32 s25, 14
  s_cbranch_scc1 L_sp_24
L_wt_23x:
  s_mov_b64 exec, -1
L_wt_23:
  s_barrier
  buffer_load_dwordx4 v[36:39], v12, s[4:7], s74 offen sc1
  s_add_u32 s74, s74, s75
  buffer_load_dwordx4 v[40:43], v12, s[4:7], s74 offen sc1
  s_add_u32 s74, s74, s75
  buffer_load_dwordx4 v[44:47], v12, s[4:7], s74 offen sc1
  s_add_u32 s74, s74, s75
  buffer_load_dwordx4 v[48:51], v12, s[4:7], s74 offen sc1
  s_add_u32 s74, s74, s75
  buffer_load_dwordx4 v[52:55], v12, s[4:7], s74 offen sc1
  s_add_u32 s74, s74, s75
  buffer_load_dwordx4 v[56:59], v12, s[4:7], s74 offen sc1
  s_add_u32 s74, s74, s75
  buffer_load_dwordx4 v[60:63], v12, s[4:7], s74 offen sc1
  s_add_u32 s74, s74, s75
  buffer_load_dwordx4 v[64:67], v12, s[4:7], s74 offen sc1
  s_add_u32 s74, s74, s75
  ds_read_b64_tr_b16 v[148:149], v13 offset:0
  ds_read_b64_tr_b16 v[150:151], v13 offset:2048
  ds_read_b64_tr_b16 v[152:153], v14 offset:0
  ds_read_b64_tr_b16 v[154:155], v14 offset:2048
  ds_read_b64_tr_b16 v[156:157], v15 offset:0
  ds_read_b64_tr_b16 v[158:159], v15 offset:2048
  ds_read_b64_tr_b16 v[160:161], v16 offset:0
  ds_read_b64_tr_b16 v[162:163], v16 offset:2048
  s_waitcnt vmcnt(7) lgkmcnt(6)
  v_mfma_f32_32x32x16_bf16 v[180:195], v[148:151], v[36:39], 0
  ds_read_b64_tr_b16 v[164:165], v13 offset:4096
  ds_read_b64_tr_b16 v[166:167], v13 offset:6144
  s_waitcnt lgkmcnt(6)
  v_mfma_f32_32x32x16_bf16 v[196:211], v[152:155], v[36:39], 0
  ds_read_b64_tr_b16 v[168:169], v14 offset:4096
  ds_read_b64_tr_b16 v[170:171], v14 offset:6144
  s_waitcnt lgkmcnt(6)
  v_mfma_f32_32x32x16_bf16 v[212:227], v[156:159], v[36:39], 0
  ds_read_b64_tr_b16 v[172:173], v15 offset:4096
  ds_read_b64_tr_b16 v[174:175], v15 offset:6144
  s_waitcnt lgkmcnt(6)
  v_mfma_f32_32x32x16_bf16 v[228:243], v[160:163], v[36:39], 0
  ds_read_b64_tr_b16 v[176:177], v16 offset:4096
  ds_read_b64_tr_b16 v[178:179], v16 offset:6144
  buffer_load_dwordx4 v[68:71], v12, s[4:7], s74 offen sc1
  s_add_u32 s74, s74, s75
  buffer_load_dwordx4 v[72:75], v12, s[4:7], s74 offen sc1
  s_add_u32 s74, s74, s75
  s_waitcnt vmcnt(8) lgkmcnt(6)
  v_mfma_f32_32x32x16_bf16 v[180:195], v[164:167], v[40:43], v[180:195]
  ds_read_b64_tr_b16 v[148:149], v13 offset:8192
  ds_read_b64_tr_b16 v[150:151], v13 offset:10240
  s_waitcnt lgkmcnt(6)
  v_mfma_f32_32x32x16_bf16 v[196:211], v[168:171], v[40:43], v[196:211]
  ds_read_b64_tr_b16 v[152:153], v14 offset:8192
  ds_read_b64_tr_b16 v[154:155], v14 offset:10240
  s_waitcnt lgkmcnt(6)
  v_mfma_f32_32x32x16_bf16 v[212:227], v[172:175], v[40:43], v[212:227]
  ds_read_b64_tr_b16 v[156:157], v15 offset:8192
  ds_read_b64_tr_b16 v[158:159], v15 offset:10240
  s_waitcnt lgkmcnt(6)
  v_mfma_f32_32x32x16_bf16 v[228:243], v[176:179], v[40:43], v[228:243]
  ds_read_b64_tr_b16 v[160:161], v16 offset:8192
  ds_read_b64_tr_b16 v[162:163], v16 offset:10240
  buffer_load_dwordx4 v[76:79], v12, s[4:7], s74 offen sc1
  s_add_u32 s74, s74, s75
  buffer_load_dwordx4 v[80:83], v12, s[4:7], s74 offen sc1
  s_add_u32 s74, s74, s75
  s_waitcnt vmcnt(9) lgkmcnt(6)
  v_mfma_f32_32x32x16_bf16 v[180:195], v[148:151], v[44:47], v[180:195]
  ds_read_b64_tr_b16 v[164:165], v13 offset:12288
  ds_read_b64_tr_b16 v[166:167], v13 offset:14336
  s_waitcnt lgkmcnt(6)
  v_mfma_f32_32x32x16_bf16 v[196:211], v[152:155], v[44:47], v[196:211]
  ds_read_b64_tr_b16 v[168:169], v14 offset:12288
  ds_read_b64_tr_b16 v[170:171], v14 offset:14336
  s_waitcnt lgkmcnt(6)
  v_mfma_f32_32x32x16_bf16 v[212:227], v[156:159], v[44:47], v[212:227]
  ds_read_b64_tr_b16 v[172:173], v15 offset:12288
  ds_read_b64_tr_b16 v[174:175], v15 offset:14336
  s_waitcnt lgkmcnt(6)
  v_mfma_f32_32x32x16_bf16 v[228:243], v[160:163], v[44:47], v[228:243]
  ds_read_b64_tr_b16 v[176:177], v16 offset:12288
  ds_read_b64_tr_b16 v[178:179], v16 offset:14336
  buffer_load_dwordx4 v[84:87], v12, s[4:7], s74 offen sc1
  s_add_u32 s74, s74, s75
  buffer_load_dwordx4 v[88:91], v12, s[4:7], s74 offen sc1
  s_add_u32 s74, s74, s75
  s_waitcnt vmcnt(10) lgkmcnt(6)
  v_mfma_f32_32x32x16_bf16 v[180:195], v[164:167], v[48:51], v[180:195]
  ds_read_b64_tr_b16 v[148:149], v13 offset:16384
  ds_read_b64_tr_b16 v[150:151], v13 offset:18432
  s_waitcnt lgkmcnt(6)
  v_mfma_f32_32x32x16_bf16 v[196:211], v[168:171], v[48:51], v[196:211]
  ds_read_b64_tr_b16 v[152:153], v14 offset:16384
  ds_read_b64_tr_b16 v[154:155], v14 offset:18432
  s_waitcnt lgkmcnt(6)
  v_mfma_f32_32x32x16_bf16 v[212:227], v[172:175], v[48:51], v[212:227]
  ds_read_b64_tr_b16 v[156:157], v15 offset:16384
  ds_read_b64_tr_b16 v[158:159], v15 offset:18432
  s_waitcnt lgkmcnt(6)
  v_mfma_f32_32x32x16_bf16 v[228:243], v[176:179], v[48:51], v[228:243]
  ds_read_b64_tr_b16 v[160:161], v16 offset:16384
  ds_read_b64_tr_b16 v[162:163], v16 offset:18432
  buffer_load_dwordx4 v[92:95], v12, s[4:7], s74 offen sc1
  s_add_u32 s74, s74, s75
  buffer_load_dwordx4 v[96:99], v12, s[4:7], s74 offen sc1
  s_add_u32 s74, s74, s75
  s_waitcnt vmcnt(11) lgkmcnt(6)
  v_mfma_f32_32x32x16_bf16 v[180:195], v[148:151], v[52:55], v[180:195]
  ds_read_b64_tr_b16 v[164:165], v13 offset:20480
  ds_read_b64_tr_b16 v[166:167], v13 offset:22528
  s_waitcnt lgkmcnt(6)
  v_mfma_f32_32x32x16_bf16 v[196:211], v[152:155], v[52:55], v[196:211]
  ds_read_b64_tr_b16 v[168:169], v14 offset:20480
  ds_read_b64_tr_b16 v[170:171], v14 offset:22528
  s_waitcnt lgkmcnt(6)
  v_mfma_f32_32x32x16_bf16 v[212:227], v[156:159], v[52:55], v[212:227]
  ds_read_b64_tr_b16 v[172:173], v15 offset:20480
  ds_read_b64_tr_b16 v[174:175], v15 offset:22528
  s_waitcnt lgkmcnt(6)
  v_mfma_f32_32x32x16_bf16 v[228:243], v[160:163], v[52:55], v[228:243]
  ds_read_b64_tr_b16 v[176:177], v16 offset:20480
  ds_read_b64_tr_b16 v[178:179], v16 offset:22528
  buffer_load_dwordx4 v[100:103], v12, s[4:7], s74 offen sc1
  s_add_u32 s74, s74, s75
  buffer_load_dwordx4 v[104:107], v12, s[4:7], s74 offen sc1
  s_add_u32 s74, s74, s75
  s_waitcnt vmcnt(12) lgkmcnt(6)
  v_mfma_f32_32x32x16_bf16 v[180:195], v[164:167], v[56:59], v[180:195]
  ds_read_b64_tr_b16 v[148:149], v13 offset:24576
  ds_read_b64_tr_b16 v[150:151], v13 offset:26624
  s_waitcnt lgkmcnt(6)
  v_mfma_f32_32x32x16_bf16 v[196:211], v[168:171], v[56:59], v[196:211]
  ds_read_b64_tr_b16 v[152:153], v14 offset:24576
  ds_read_b64_tr_b16 v[154:155], v14 offset:26624
  s_waitcnt lgkmcnt(6)
  v_mfma_f32_32x32x16_bf16 v[212:227], v[172:175], v[56:59], v[212:227]
  ds_read_b64_tr_b16 v[156:157], v15 offset:24576
  ds_read_b64_tr_b16 v[158:159], v15 offset:26624
  s_waitcnt lgkmcnt(6)
  v_mfma_f32_32x32x16_bf16 v[228:243], v[176:179], v[56:59], v[228:243]
  ds_read_b64_tr_b16 v[160:161], v16 offset:24576
  ds_read_b64_tr_b16 v[162:163], v16 offset:26624
  buffer_load_dwordx4 v[108:111], v12, s[4:7], s74 offen sc1
  s_add_u32 s74, s74, s75
  buffer_load_dwordx4 v[112:115], v12, s[4:7], s74 offen sc1
  s_add_u32 s74, s74, s75
  s_waitcnt vmcnt(13) lgkmcnt(6)
  v_mfma_f32_32x32x16_bf16 v[180:195], v[148:151], v[60:63], v[180:195]
  ds_read_b64_tr_b16 v[164:165], v13 offset:28672
  ds_read_b64_tr_b16 v[166:167], v13 offset:30720
  s_waitcnt lgkmcnt(6)
  v_mfma_f32_32x32x16_bf16 v[196:211], v[152:155], v[60:63], v[196:211]
  ds_read_b64_tr_b16 v[168:169], v14 offset:28672
  ds_read_b64_tr_b16 v[170:171], v14 offset:30720
  s_waitcnt lgkmcnt(6)
  v_mfma_f32_32x32x16_bf16 v[212:227], v[156:159], v[60:63], v[212:227]
  ds_read_b64_tr_b16 v[172:173], v15 offset:28672
  ds_read_b64_tr_b16 v[174:175], v15 offset:30720
  s_waitcnt lgkmcnt(6)
  v_mfma_f32_32x32x16_bf16 v[228:243], v[160:163], v[60:63], v[228:243]
  ds_read_b64_tr_b16 v[176:177], v16 offset:28672
  ds_read_b64_tr_b16 v[178:179], v16 offset:30720
  buffer_load_dwordx4 v[116:119], v12, s[4:7], s74 offen sc1
  s_add_u32 s74, s74, s75
  buffer_load_dwordx4 v[120:123], v12, s[4:7], s74 offen sc1
  s_add_u32 s74, s74, s75
  s_waitcnt vmcnt(14) lgkmcnt(6)
  v_mfma_f32_32x32x16_bf16 v[180:195], v[164:167], v[64:67], v[180:195]
  ds_read_b64_tr_b16 v[148:149], v13 offset:32768
  ds_read_b64_tr_b16 v[150:151], v13 offset:34816
  s_waitcnt lgkmcnt(6)
  v_mfma_f32_32x32x16_bf16 v[196:211], v[168:171], v[64:67], v[196:211]
  ds_read_b64_tr_b16 v[152:153], v14 offset:32768
  ds_read_b64_tr_b16 v[154:155], v14 offset:34816
  s_waitcnt lgkmcnt(6)
  v_mfma_f32_32x32x16_bf16 v[212:227], v[172:175], v[64:67], v[212:227]
  ds_read_b64_tr_b16 v[156:157], v15 offset:32768
  ds_read_b64_tr_b16 v[158:159], v15 offset:34816
  s_waitcnt lgkmcnt(6)
  v_mfma_f32_32x32x16_bf16 v[228:243], v[176:179], v[64:67], v[228:243]
  ds_read_b64_tr_b16 v[160:161], v16 offset:32768
  ds_read_b64_tr_b16 v[162:163], v16 offset:34816
  buffer_load_dwordx4 v[124:127], v12, s[4:7], s74 offen sc1
  s_add_u32 s74, s74, s75
  buffer_load_dwordx4 v[128:131], v12, s[4:7], s74 offen sc1
  s_add_u32 s74, s74, s75
  s_waitcnt vmcnt(15) lgkmcnt(6)
  v_mfma_f32_32x32x16_bf16 v[180:195], v[148:151], v[68:71], v[180:195]
  ds_read_b64_tr_b16 v[164:165], v13 offset:36864
  ds_read_b64_tr_b16 v[166:167], v13 offset:38912
  s_waitcnt lgkmcnt(6)
  v_mfma_f32_32x32x16_bf16 v[196:211], v[152:155], v[68:71], v[196:211]
  ds_read_b64_tr_b16 v[168:169], v14 offset:36864
  ds_read_b64_tr_b16 v[170:171], v14 offset:38912
  s_waitcnt lgkmcnt(6)
  v_mfma_f32_32x32x16_bf16 v[212:227], v[156:159], v[68:71], v[212:227]
  ds_read_b64_tr_b16 v[172:173], v15 offset:36864
  ds_read_b64_tr_b16 v[174:175], v15 offset:38912
  s_waitcnt lgkmcnt(6)
  v_mfma_f32_32x32x16_bf16 v[228:243], v[160:163], v[68:71], v[228:243]
  ds_read_b64_tr_b16 v[176:177], v16 offset:36864
  ds_read_b64_tr_b16 v[178:179], v16 offset:38912
  buffer_load_dwordx4 v[132:135], v12, s[4:7], s74 offen sc1
  s_add_u32 s74, s74, s75
  buffer_load_dwordx4 v[136:139], v12, s[4:7], s74 offen sc1
  s_add_u32 s74, s74, s75
  s_waitcnt vmcnt(16) lgkmcnt(6)
  v_mfma_f32_32x32x16_bf16 v[180:195], v[164:167], v[72:75], v[180:195]
  ds_read_b64_tr_b16 v[148:149], v13 offset:40960
  ds_read_b64_tr_b16 v[150:151], v13 offset:43008
  s_waitcnt lgkmcnt(6)
  v_mfma_f32_32x32x16_bf16 v[196:211], v[168:171], v[72:75], v[196:211]
  ds_read_b64_tr_b16 v[152:153], v14 offset:40960
  ds_read_b64_tr_b16 v[154:155], v14 offset:43008
  s_waitcnt lgkmcnt(6)
  v_mfma_f32_32x32x16_bf16 v[212:227], v[172:175], v[72:75], v[212:227]
  ds_read_b64_tr_b16 v[156:157], v15 offset:40960
  ds_read_b64_tr_b16 v[158:159], v15 offset:43008
  s_waitcnt lgkmcnt(6)
  v_mfma_f32_32x32x16_bf16 v[228:243], v[176:179], v[72:75], v[228:243]
  ds_read_b64_tr_b16 v[160:161], v16 offset:40960
  ds_read_b64_tr_b16 v[162:163], v16 offset:43008
  buffer_load_dwordx4 v[140:143], v12, s[4:7], s74 offen sc1
  s_add_u32 s74, s74, s75
  s_waitcnt vmcnt(16) lgkmcnt(6)
  v_mfma_f32_32x32x16_bf16 v[180:195], v[148:151], v[76:79], v[180:195]
  ds_read_b64_tr_b16 v[164:165], v13 offset:45056
  ds_read_b64_tr_b16 v[166:167], v13 offset:47104
  s_waitcnt lgkmcnt(6)
  v_mfma_f32_32x32x16_bf16 v[196:211], v[152:155], v[76:79], v[196:211]
  ds_read_b64_tr_b16 v[168:169], v14 offset:45056
  ds_read_b64_tr_b16 v[170:171], v14 offset:47104
  s_waitcnt lgkmcnt(6)
  v_mfma_f32_32x32x16_bf16 v[212:227], v[156:159], v[76:79], v[212:227]
  ds_read_b64_tr_b16 v[172:173], v15 offset:45056
  ds_read_b64_tr_b16 v[174:175], v15 offset:47104
  s_waitcnt lgkmcnt(6)
  v_mfma_f32_32x32x16_bf16 v[228:243], v[160:163], v[76:79], v[228:243]
  ds_read_b64_tr_b16 v[176:177], v16 offset:45056
  ds_read_b64_tr_b16 v[178:179], v16 offset:47104
  buffer_load_dwordx4 v[144:147], v12, s[4:7], s74 offen sc1
  s_add_u32 s74, s74, s75
  s_waitcnt vmcnt(16) lgkmcnt(6)
  v_mfma_f32_32x32x16_bf16 v[180:195], v[164:167], v[80:83], v[180:195]
  ds_read_b64_tr_b16 v[148:149], v13 offset:49152
  ds_read_b64_tr_b16 v[150:151], v13 offset:51200
  s_waitcnt lgkmcnt(6)
  v_mfma_f32_32x32x16_bf16 v[196:211], v[168:171], v[80:83], v[196:211]
  ds_read_b64_tr_b16 v[152:153], v14 offset:49152
  ds_read_b64_tr_b16 v[154:155], v14 offset:51200
  s_waitcnt lgkmcnt(6)
  v_mfma_f32_32x32x16_bf16 v[212:227], v[172:175], v[80:83], v[212:227]
  ds_read_b64_tr_b16 v[156:157], v15 offset:49152
  ds_read_b64_tr_b16 v[158:159], v15 offset:51200
  s_waitcnt lgkmcnt(6)
  v_mfma_f32_32x32x16_bf16 v[228:243], v[176:179], v[80:83], v[228:243]
  ds_read_b64_tr_b16 v[160:161], v16 offset:49152
  ds_read_b64_tr_b16 v[162:163], v16 offset:51200
  s_waitcnt vmcnt(15) lgkmcnt(6)
  v_mfma_f32_32x32x16_bf16 v[180:195], v[148:151], v[84:87], v[180:195]
  ds_read_b64_tr_b16 v[164:165], v13 offset:53248
  ds_read_b64_tr_b16 v[166:167], v13 offset:55296
  s_waitcnt lgkmcnt(6)
  v_mfma_f32_32x32x16_bf16 v[196:211], v[152:155], v[84:87], v[196:211]
  ds_read_b64_tr_b16 v[168:169], v14 offset:53248
  ds_read_b64_tr_b16 v[170:171], v14 offset:55296
  s_waitcnt lgkmcnt(6)
  v_mfma_f32_32x32x16_bf16 v[212:227], v[156:159], v[84:87], v[212:227]
  ds_read_b64_tr_b16 v[172:173], v15 offset:53248
  ds_read_b64_tr_b16 v[174:175], v15 offset:55296
  s_waitcnt lgkmcnt(6)
  v_mfma_f32_32x32x16_bf16 v[228:243], v[160:163], v[84:87], v[228:243]
  ds_read_b64_tr_b16 v[176:177], v16 offset:53248
  ds_read_b64_tr_b16 v[178:179], v16 offset:55296
  s_waitcnt vmcnt(14) lgkmcnt(6)
  v_mfma_f32_32x32x16_bf16 v[180:195], v[164:167], v[88:91], v[180:195]
  ds_read_b64_tr_b16 v[148:149], v13 offset:57344
  ds_read_b64_tr_b16 v[150:151], v13 offset:59392
  s_waitcnt lgkmcnt(6)
  v_mfma_f32_32x32x16_bf16 v[196:211], v[168:171], v[88:91], v[196:211]
  ds_read_b64_tr_b16 v[152:153], v14 offset:57344
  ds_read_b64_tr_b16 v[154:155], v14 offset:59392
  s_waitcnt lgkmcnt(6)
  v_mfma_f32_32x32x16_bf16 v[212:227], v[172:175], v[88:91], v[212:227]
  ds_read_b64_tr_b16 v[156:157], v15 offset:57344
  ds_read_b64_tr_b16 v[158:159], v15 offset:59392
  s_waitcnt lgkmcnt(6)
  v_mfma_f32_32x32x16_bf16 v[228:243], v[176:179], v[88:91], v[228:243]
  ds_read_b64_tr_b16 v[160:161], v16 offset:57344
  ds_read_b64_tr_b16 v[162:163], v16 offset:59392
  s_waitcnt vmcnt(13) lgkmcnt(6)
  v_mfma_f32_32x32x16_bf16 v[180:195], v[148:151], v[92:95], v[180:195]
  ds_read_b64_tr_b16 v[164:165], v13 offset:61440
  ds_read_b64_tr_b16 v[166:167], v13 offset:63488
  s_waitcnt lgkmcnt(6)
  v_mfma_f32_32x32x16_bf16 v[196:211], v[152:155], v[92:95], v[196:211]
  ds_read_b64_tr_b16 v[168:169], v14 offset:61440
  ds_read_b64_tr_b16 v[170:171], v14 offset:63488
  s_waitcnt lgkmcnt(6)
  v_mfma_f32_32x32x16_bf16 v[212:227], v[156:159], v[92:95], v[212:227]
  ds_read_b64_tr_b16 v[172:173], v15 offset:61440
  ds_read_b64_tr_b16 v[174:175], v15 offset:63488
  s_waitcnt lgkmcnt(6)
  v_mfma_f32_32x32x16_bf16 v[228:243], v[160:163], v[92:95], v[228:243]
  ds_read_b64_tr_b16 v[176:177], v16 offset:61440
  ds_read_b64_tr_b16 v[178:179], v16 offset:63488
  s_waitcnt vmcnt(12) lgkmcnt(6)
  v_mfma_f32_32x32x16_bf16 v[180:195], v[164:167], v[96:99], v[180:195]
  v_add_u32 v13, 0x10000, v13
  ds_read_b64_tr_b16 v[148:149], v13 offset:0
  ds_read_b64_tr_b16 v[150:151], v13 offset:2048
  s_waitcnt lgkmcnt(6)
  v_mfma_f32_32x32x16_bf16 v[196:211], v[168:171], v[96:99], v[196:211]
  v_add_u32 v14, 0x10000, v14
  ds_read_b64_tr_b16 v[152:153], v14 offset:0
  ds_read_b64_tr_b16 v[154:155], v14 offset:2048
  s_waitcnt lgkmcnt(6)
  v_mfma_f32_32x32x16_bf16 v[212:227], v[172:175], v[96:99], v[212:227]
  v_add_u32 v15, 0x10000, v15
  ds_read_b64_tr_b16 v[156:157], v15 offset:0
  ds_read_b64_tr_b16 v[158:159], v15 offset:2048
  s_waitcnt lgkmcnt(6)
  v_mfma_f32_32x32x16_bf16 v[228:243], v[176:179], v[96:99], v[228:243]
  v_add_u32 v16, 0x10000, v16
  ds_read_b64_tr_b16 v[160:161], v16 offset:0
  ds_read_b64_tr_b16 v[162:163], v16 offset:2048
  s_waitcnt vmcnt(11) lgkmcnt(6)
  v_mfma_f32_32x32x16_bf16 v[180:195], v[148:151], v[100:103], v[180:195]
  ds_read_b64_tr_b16 v[164:165], v13 offset:4096
  ds_read_b64_tr_b16 v[166:167], v13 offset:6144
  s_waitcnt lgkmcnt(6)
  v_mfma_f32_32x32x16_bf16 v[196:211], v[152:155], v[100:103], v[196:211]
  ds_read_b64_tr_b16 v[168:169], v14 offset:4096
  ds_read_b64_tr_b16 v[170:171], v14 offset:6144
  s_waitcnt lgkmcnt(6)
  v_mfma_f32_32x32x16_bf16 v[212:227], v[156:159], v[100:103], v[212:227]
  ds_read_b64_tr_b16 v[172:173], v15 offset:4096
  ds_read_b64_tr_b16 v[174:175], v15 offset:6144
  s_waitcnt lgkmcnt(6)
  v_mfma_f32_32x32x16_bf16 v[228:243], v[160:163], v[100:103], v[228:243]
  ds_read_b64_tr_b16 v[176:177], v16 offset:4096
  ds_read_b64_tr_b16 v[178:179], v16 offset:6144
  v_lshlrev_b32 v5, 8, v2
  v_lshl_add_u32 v5, v4, 3, v5
  buffer_load_dwordx2 v[22:23], v5, s[8:11], 0 offen offset:0 sc1
  buffer_load_dwordx2 v[24:25], v5, s[8:11], 0 offen offset:512 sc1
  buffer_load_dwordx2 v[26:27], v5, s[8:11], 0 offen offset:1024 sc1
  buffer_load_dwordx2 v[28:29], v5, s[8:11], 0 offen offset:1536 sc1
  buffer_load_dwordx2 v[30:31], v5, s[8:11], 0 offen offset:2048 sc1
  buffer_load_dwordx2 v[32:33], v5, s[8:11], 0 offen offset:2560 sc1
  buffer_load_dwordx2 v[34:35], v5, s[8:11], 0 offen offset:3072 sc1
  s_waitcnt vmcnt(17) lgkmcnt(6)
  v_mfma_f32_32x32x16_bf16 v[180:195], v[164:167], v[104:107], v[180:195]
  ds_read_b64_tr_b16 v[148:149], v13 offset:8192
  ds_read_b64_tr_b16 v[150:151], v13 offset:10240
  s_waitcnt lgkmcnt(6)
  v_mfma_f32_32x32x16_bf16 v[196:211], v[168:171], v[104:107], v[196:211]
  ds_read_b64_tr_b16 v[152:153], v14 offset:8192
  ds_read_b64_tr_b16 v[154:155], v14 offset:10240
  s_waitcnt lgkmcnt(6)
  v_mfma_f32_32x32x16_bf16 v[212:227], v[172:175], v[104:107], v[212:227]
  ds_read_b64_tr_b16 v[156:157], v15 offset:8192
  ds_read_b64_tr_b16 v[158:159], v15 offset:10240
  s_waitcnt lgkmcnt(6)
  v_mfma_f32_32x32x16_bf16 v[228:243], v[176:179], v[104:107], v[228:243]
  ds_read_b64_tr_b16 v[160:161], v16 offset:8192
  ds_read_b64_tr_b16 v[162:163], v16 offset:10240
  s_waitcnt vmcnt(16) lgkmcnt(6)
  v_mfma_f32_32x32x16_bf16 v[180:195], v[148:151], v[108:111], v[180:195]
  ds_read_b64_tr_b16 v[164:165], v13 offset:12288
  ds_read_b64_tr_b16 v[166:167], v13 offset:14336
  s_waitcnt lgkmcnt(6)
  v_mfma_f32_32x32x16_bf16 v[196:211], v[152:155], v[108:111], v[196:211]
  ds_read_b64_tr_b16 v[168:169], v14 offset:12288
  ds_read_b64_tr_b16 v[170:171], v14 offset:14336
  s_waitcnt lgkmcnt(6)
  v_mfma_f32_32x32x16_bf16 v[212:227], v[156:159], v[108:111], v[212:227]
  ds_read_b64_tr_b16 v[172:173], v15 offset:12288
  ds_read_b64_tr_b16 v[174:175], v15 offset:14336
  s_waitcnt lgkmcnt(6)
  v_mfma_f32_32x32x16_bf16 v[228:243], v[160:163], v[108:111], v[228:243]
  ds_read_b64_tr_b16 v[176:177], v16 offset:12288
  ds_read_b64_tr_b16 v[178:179], v16 offset:14336
  s_waitcnt vmcnt(15) lgkmcnt(6)
  v_mfma_f32_32x32x16_bf16 v[180:195], v[164:167], v[112:115], v[180:195]
  ds_read_b64_tr_b16 v[148:149], v13 offset:16384
  ds_read_b64_tr_b16 v[150:151], v13 offset:18432
  s_waitcnt lgkmcnt(6)
  v_mfma_f32_32x32x16_bf16 v[196:211], v[168:171], v[112:115], v[196:211]
  ds_read_b64_tr_b16 v[152:153], v14 offset:16384
  ds_read_b64_tr_b16 v[154:155], v14 offset:18432
  s_waitcnt lgkmcnt(6)
  v_mfma_f32_32x32x16_bf16 v[212:227], v[172:175], v[112:115], v[212:227]
  ds_read_b64_tr_b16 v[156:157], v15 offset:16384
  ds_read_b64_tr_b16 v[158:159], v15 offset:18432
  s_waitcnt lgkmcnt(6)
  v_mfma_f32_32x32x16_bf16 v[228:243], v[176:179], v[112:115], v[228:243]
  ds_read_b64_tr_b16 v[160:161], v16 offset:16384
  ds_read_b64_tr_b16 v[162:163], v16 offset:18432
  s_waitcnt vmcnt(14) lgkmcnt(6)
  v_mfma_f32_32x32x16_bf16 v[180:195], v[148:151], v[116:119], v[180:195]
  ds_read_b64_tr_b16 v[164:165], v13 offset:20480
  ds_read_b64_tr_b16 v[166:167], v13 offset:22528
  s_waitcnt lgkmcnt(6)
  v_mfma_f32_32x32x16_bf16 v[196:211], v[152:155], v[116:119], v[196:211]
  ds_read_b64_tr_b16 v[168:169], v14 offset:20480
  ds_read_b64_tr_b16 v[170:171], v14 offset:22528
  s_waitcnt lgkmcnt(6)
  v_mfma_f32_32x32x16_bf16 v[212:227], v[156:159], v[116:119], v[212:227]
  ds_read_b64_tr_b16 v[172:173], v15 offset:20480
  ds_read_b64_tr_b16 v[174:175], v15 offset:22528
  s_waitcnt lgkmcnt(6)
  v_mfma_f32_32x32x16_bf16 v[228:243], v[160:163], v[116:119], v[228:243]
  ds_read_b64_tr_b16 v[176:177], v16 offset:20480
  ds_read_b64_tr_b16 v[178:179], v16 offset:22528
  s_waitcnt vmcnt(13) lgkmcnt(6)
  v_mfma_f32_32x32x16_bf16 v[180:195], v[164:167], v[120:123], v[180:195]
  ds_read_b64_tr_b16 v[148:149], v13 offset:24576
  ds_read_b64_tr_b16 v[150:151], v13 offset:26624
  s_waitcnt lgkmcnt(6)
  v_mfma_f32_32x32x16_bf16 v[196:211], v[168:171], v[120:123], v[196:211]
  ds_read_b64_tr_b16 v[152:153], v14 offset:24576
  ds_read_b64_tr_b16 v[154:155], v14 offset:26624
  s_waitcnt lgkmcnt(6)
  v_mfma_f32_32x32x16_bf16 v[212:227], v[172:175], v[120:123], v[212:227]
  ds_read_b64_tr_b16 v[156:157], v15 offset:24576
  ds_read_b64_tr_b16 v[158:159], v15 offset:26624
  s_waitcnt lgkmcnt(6)
  v_mfma_f32_32x32x16_bf16 v[228:243], v[176:179], v[120:123], v[228:243]
  ds_read_b64_tr_b16 v[160:161], v16 offset:24576
  ds_read_b64_tr_b16 v[162:163], v16 offset:26624
  s_waitcnt vmcnt(12) lgkmcnt(6)
  v_mfma_f32_32x32x16_bf16 v[180:195], v[148:151], v[124:127], v[180:195]
  ds_read_b64_tr_b16 v[164:165], v13 offset:28672
  ds_read_b64_tr_b16 v[166:167], v13 offset:30720
  s_waitcnt lgkmcnt(6)
  v_mfma_f32_32x32x16_bf16 v[196:211], v[152:155], v[124:127], v[196:211]
  ds_read_b64_tr_b16 v[168:169], v14 offset:28672
  ds_read_b64_tr_b16 v[170:171], v14 offset:30720
  s_waitcnt lgkmcnt(6)
  v_mfma_f32_32x32x16_bf16 v[212:227], v[156:159], v[124:127], v[212:227]
  ds_read_b64_tr_b16 v[172:173], v15 offset:28672
  ds_read_b64_tr_b16 v[174:175], v15 offset:30720
  s_waitcnt lgkmcnt(6)
  v_mfma_f32_32x32x16_bf16 v[228:243], v[160:163], v[124:127], v[228:243]
  ds_read_b64_tr_b16 v[176:177], v16 offset:28672
  ds_read_b64_tr_b16 v[178:179], v16 offset:30720
  s_waitcnt vmcnt(11) lgkmcnt(6)
  v_mfma_f32_32x32x16_bf16 v[180:195], v[164:167], v[128:131], v[180:195]
  ds_read_b64_tr_b16 v[148:149], v13 offset:32768
  ds_read_b64_tr_b16 v[150:151], v13 offset:34816
  s_waitcnt lgkmcnt(6)
  v_mfma_f32_32x32x16_bf16 v[196:211], v[168:171], v[128:131], v[196:211]
  ds_read_b64_tr_b16 v[152:153], v14 offset:32768
  ds_read_b64_tr_b16 v[154:155], v14 offset:34816
  s_waitcnt lgkmcnt(6)
  v_mfma_f32_32x32x16_bf16 v[212:227], v[172:175], v[128:131], v[212:227]
  ds_read_b64_tr_b16 v[156:157], v15 offset:32768
  ds_read_b64_tr_b16 v[158:159], v15 offset:34816
  s_waitcnt lgkmcnt(6)
  v_mfma_f32_32x32x16_bf16 v[228:243], v[176:179], v[128:131], v[228:243]
  ds_read_b64_tr_b16 v[160:161], v16 offset:32768
  ds_read_b64_tr_b16 v[162:163], v16 offset:34816
  s_waitcnt vmcnt(10) lgkmcnt(6)
  v_mfma_f32_32x32x16_bf16 v[180:195], v[148:151], v[132:135], v[180:195]
  ds_read_b64_tr_b16 v[164:165], v13 offset:36864
  ds_read_b64_tr_b16 v[166:167], v13 offset:38912
  s_waitcnt lgkmcnt(6)
  v_mfma_f32_32x32x16_bf16 v[196:211], v[152:155], v[132:135], v[196:211]
  ds_read_b64_tr_b16 v[168:169], v14 offset:36864
  ds_read_b64_tr_b16 v[170:171], v14 offset:38912
  s_waitcnt lgkmcnt(6)
  v_mfma_f32_32x32x16_bf16 v[212:227], v[156:159], v[132:135], v[212:227]
  ds_read_b64_tr_b16 v[172:173], v15 offset:36864
  ds_read_b64_tr_b16 v[174:175], v15 offset:38912
  s_waitcnt lgkmcnt(6)
  v_mfma_f32_32x32x16_bf16 v[228:243], v[160:163], v[132:135], v[228:243]
  ds_read_b64_tr_b16 v[176:177], v16 offset:36864
  ds_read_b64_tr_b16 v[178:179], v16 offset:38912
  s_waitcnt vmcnt(9) lgkmcnt(6)
  v_mfma_f32_32x32x16_bf16 v[180:195], v[164:167], v[136:139], v[180:195]
  ds_read_b64_tr_b16 v[148:149], v13 offset:40960
  ds_read_b64_tr_b16 v[150:151], v13 offset:43008
  s_waitcnt lgkmcnt(6)
  v_mfma_f32_32x32x16_bf16 v[196:211], v[168:171], v[136:139], v[196:211]
  ds_read_b64_tr_b16 v[152:153], v14 offset:40960
  ds_read_b64_tr_b16 v[154:155], v14 offset:43008
  s_waitcnt lgkmcnt(6)
  v_mfma_f32_32x32x16_bf16 v[212:227], v[172:175], v[136:139], v[212:227]
  ds_read_b64_tr_b16 v[156:157], v15 offset:40960
  ds_read_b64_tr_b16 v[158:159], v15 offset:43008
  s_waitcnt lgkmcnt(6)
  v_mfma_f32_32x32x16_bf16 v[228:243], v[176:179], v[136:139], v[228:243]
  ds_read_b64_tr_b16 v[160:161], v16 offset:40960
  ds_read_b64_tr_b16 v[162:163], v16 offset:43008
  s_waitcnt vmcnt(8) lgkmcnt(6)
  v_mfma_f32_32x32x16_bf16 v[180:195], v[148:151], v[140:143], v[180:195]
  ds_read_b64_tr_b16 v[164:165], v13 offset:45056
  ds_read_b64_tr_b16 v[166:167], v13 offset:47104
  s_waitcnt lgkmcnt(6)
  v_mfma_f32_32x32x16_bf16 v[196:211], v[152:155], v[140:143], v[196:211]
  ds_read_b64_tr_b16 v[168:169], v14 offset:45056
  ds_read_b64_tr_b16 v[170:171], v14 offset:47104
  s_waitcnt lgkmcnt(6)
  v_mfma_f32_32x32x16_bf16 v[212:227], v[156:159], v[140:143], v[212:227]
  ds_read_b64_tr_b16 v[172:173], v15 offset:45056
  ds_read_b64_tr_b16 v[174:175], v15 offset:47104
  s_waitcnt lgkmcnt(6)
  v_mfma_f32_32x32x16_bf16 v[228:243], v[160:163], v[140:143], v[228:243]
  ds_read_b64_tr_b16 v[176:177], v16 offset:45056
  ds_read_b64_tr_b16 v[178:179], v16 offset:47104
  s_waitcnt vmcnt(7) lgkmcnt(6)
  v_mfma_f32_32x32x16_bf16 v[180:195], v[164:167], v[144:147], v[180:195]
  s_waitcnt lgkmcnt(4)
  v_mfma_f32_32x32x16_bf16 v[196:211], v[168:171], v[144:147], v[196:211]
  s_waitcnt lgkmcnt(2)
  v_mfma_f32_32x32x16_bf16 v[212:227], v[172:175], v[144:147], v[212:227]
  s_waitcnt lgkmcnt(0)
  v_mfma_f32_32x32x16_bf16 v[228:243], v[176:179], v[144:147], v[228:243]
  s_waitcnt vmcnt(0)
  v_lshlrev_b32 v6, 2, v4
  v_add_u32 v6, 162816, v6
  ds_read_b32 v132, v6 offset:0
  ds_read_b32 v133, v6 offset:128
  ds_read_b32 v134, v6 offset:256
  ds_read_b32 v135, v6 offset:384
  v_pk_add_f32 v[24:25], v[24:25], v[26:27]
  v_pk_add_f32 v[28:29], v[28:29], v[30:31]
  v_pk_add_f32 v[32:33], v[32:33], v[34:35]
  v_pk_add_f32 v[22:23], v[22:23], v[24:25]
  v_pk_add_f32 v[28:29], v[28:29], v[32:33]
  v_pk_add_f32 v[22:23], v[22:23], v[28:29]
  v_mov_b32 v5, v22
  s_nop 1
  v_permlane32_swap_b32 v22, v5
  v_add_f32 v22, v22, v5
  v_mov_b32 v6, v23
  s_nop 1
  v_permlane32_swap_b32 v23, v6
  v_add_f32 v23, v23, v6
  v_mul_f32 v136, 0x3b124925, v22
  v_mul_f32 v5, 0x3b124925, v23
  v_fma_f32 v5, -v136, v136, v5
  v_max_f32 v5, 0, v5
  v_add_f32 v5, 0x3727c5ac, v5
  v_rsq_f32 v138, v5
  s_nop 0
  v_mul_f32 v140, v5, v138
  v_sub_f32 v7, 0, v136
  v_cvt_pk_bf16_f32 v8, v7, v7
  v_and_b32 v8, 0xffff0000, v8
  v_sub_f32 v8, v7, v8
  v_cvt_pk_bf16_f32 v36, v7, v8
  v_mov_b32 v37, v36
  v_cvt_pk_bf16_f32 v8, v140, v140
  v_and_b32 v8, 0xffff0000, v8
  v_sub_f32 v8, v140, v8
  v_cvt_pk_bf16_f32 v38, v140, v8
  v_mov_b32 v39, 0
  v_mov_b32 v8, 0
  v_cndmask_b32 v36, v36, v8, s[50:51]
  v_cndmask_b32 v37, v37, v8, s[50:51]
  v_cndmask_b32 v38, v38, v8, s[50:51]
  s_waitcnt lgkmcnt(0)
  v_cvt_pk_bf16_f32 v148, v132, v132
  v_and_b32 v8, 0xffff0000, v148
  v_sub_f32 v8, v132, v8
  v_cvt_pk_bf16_f32 v149, v8, v8
  v_lshl_or_b32 v150, v17, 16, v17
  v_mov_b32 v151, 0
  v_cvt_pk_bf16_f32 v152, v133, v133
  v_and_b32 v8, 0xffff0000, v152
  v_sub_f32 v8, v133, v8
  v_cvt_pk_bf16_f32 v153, v8, v8
  v_lshl_or_b32 v154, v18, 16, v18
  v_mov_b32 v155, 0
  v_cvt_pk_bf16_f32 v156, v134, v134
  v_and_b32 v8, 0xffff0000, v156
  v_sub_f32 v8, v134, v8
  v_cvt_pk_bf16_f32 v157, v8, v8
  v_lshl_or_b32 v158, v19, 16, v19
  v_mov_b32 v159, 0
  v_cvt_pk_bf16_f32 v160, v135, v135
  v_and_b32 v8, 0xffff0000, v160
  v_sub_f32 v8, v135, v8
  v_cvt_pk_bf16_f32 v161, v8, v8
  v_lshl_or_b32 v162, v20, 16, v20
  v_mov_b32 v163, 0
  v_mfma_f32_32x32x16_bf16 v[180:195], v[148:151], v[36:39], v[180:195]
  v_mfma_f32_32x32x16_bf16 v[196:211], v[152:155], v[36:39], v[196:211]
  v_mfma_f32_32x32x16_bf16 v[212:227], v[156:159], v[36:39], v[212:227]
  v_mfma_f32_32x32x16_bf16 v[228:243], v[160:163], v[36:39], v[228:243]
  s_add_u32 s25, s72, 10485760
  s_add_u32 s12, s48, s25
  s_addc_u32 s13, s49, 0
  s_and_b32 s13, s13, 0xffff
  s_mov_b32 s14, 7340032
  s_mov_b32 s15, 0x20000
  s_mul_i32 s75, s62, 112
  s_lshl_b32 s26, s61, 3
  s_add_u32 s75, s75, s26
  s_lshl_b32 s75, s75, 10
  v_mul_f32 v142, 0xc0135761, v138
  v_mul_f32 v5, v138, v138
  v_mul_f32 v5, v5, v138
  v_mul_f32 v144, 0xbdd2d3e8, v5
  v_mov_b32 v143, v142
  v_mov_b32 v145, v144
  v_mov_b32 v141, v140
  v_pk_mul_f32 v[52:53], v[180:181], v[180:181]
  v_pk_mul_f32 v[54:55], v[182:183], v[182:183]
  v_pk_mul_f32 v[56:57], v[184:185], v[184:185]
  v_pk_mul_f32 v[58:59], v[186:187], v[186:187]
  v_pk_mul_f32 v[60:61], v[188:189], v[188:189]
  v_pk_mul_f32 v[62:63], v[190:191], v[190:191]
  v_pk_mul_f32 v[64:65], v[192:193], v[192:193]
  v_pk_mul_f32 v[66:67], v[194:195], v[194:195]
  v_pk_fma_f32 v[52:53], v[52:53], v[144:145], v[142:143]
  v_pk_fma_f32 v[54:55], v[54:55], v[144:145], v[142:143]
  v_pk_fma_f32 v[56:57], v[56:57], v[144:145], v[142:143]
  v_pk_fma_f32 v[58:59], v[58:59], v[144:145], v[142:143]
  v_pk_fma_f32 v[60:61], v[60:61], v[144:145], v[142:143]
  v_pk_fma_f32 v[62:63], v[62:63], v[144:145], v[142:143]
  v_pk_fma_f32 v[64:65], v[64:65], v[144:145], v[142:143]
  v_pk_fma_f32 v[66:67], v[66:67], v[144:145], v[142:143]
  v_pk_mul_f32 v[52:53], v[52:53], v[180:181]
  v_pk_mul_f32 v[54:55], v[54:55], v[182:183]
  v_pk_mul_f32 v[56:57], v[56:57], v[184:185]
  v_pk_mul_f32 v[58:59], v[58:59], v[186:187]
  v_pk_mul_f32 v[60:61], v[60:61], v[188:189]
  v_pk_mul_f32 v[62:63], v[62:63], v[190:191]
  v_pk_mul_f32 v[64:65], v[64:65], v[192:193]
  v_pk_mul_f32 v[66:67], v[66:67], v[194:195]
  v_exp_f32 v52, v52
  v_exp_f32 v53, v53
  v_exp_f32 v54, v54
  v_exp_f32 v55, v55
  v_exp_f32 v56, v56
  v_exp_f32 v57, v57
  v_exp_f32 v58, v58
  v_exp_f32 v59, v59
  v_exp_f32 v60, v60
  v_exp_f32 v61, v61
  v_exp_f32 v62, v62
  v_exp_f32 v63, v63
  v_exp_f32 v64, v64
  v_exp_f32 v65, v65
  v_exp_f32 v66, v66
  v_exp_f32 v67, v67
  v_pk_fma_f32 v[52:53], v[52:53], v[140:141], v[140:141]
  v_pk_fma_f32 v[54:55], v[54:55], v[140:141], v[140:141]
  v_pk_fma_f32 v[56:57], v[56:57], v[140:141], v[140:141]
  v_pk_fma_f32 v[58:59], v[58:59], v[140:141], v[140:141]
  v_pk_fma_f32 v[60:61], v[60:61], v[140:141], v[140:141]
  v_pk_fma_f32 v[62:63], v[62:63], v[140:141], v[140:141]
  v_pk_fma_f32 v[64:65], v[64:65], v[140:141], v[140:141]
  v_pk_fma_f32 v[66:67], v[66:67], v[140:141], v[140:141]
  v_rcp_f32 v52, v52
  v_rcp_f32 v53, v53
  v_rcp_f32 v54, v54
  v_rcp_f32 v55, v55
  v_rcp_f32 v56, v56
  v_rcp_f32 v57, v57
  v_rcp_f32 v58, v58
  v_rcp_f32 v59, v59
  v_rcp_f32 v60, v60
  v_rcp_f32 v61, v61
  v_rcp_f32 v62, v62
  v_rcp_f32 v63, v63
  v_rcp_f32 v64, v64
  v_rcp_f32 v65, v65
  v_rcp_f32 v66, v66
  v_rcp_f32 v67, v67
  v_pk_mul_f32 v[180:181], v[180:181], v[52:53]
  v_pk_mul_f32 v[182:183], v[182:183], v[54:55]
  v_pk_mul_f32 v[184:185], v[184:185], v[56:57]
  v_pk_mul_f32 v[186:187], v[186:187], v[58:59]
  v_pk_mul_f32 v[188:189], v[188:189], v[60:61]
  v_pk_mul_f32 v[190:191], v[190:191], v[62:63]
  v_pk_mul_f32 v[192:193], v[192:193], v[64:65]
  v_pk_mul_f32 v[194:195], v[194:195], v[66:67]
  v_cvt_pk_bf16_f32 v84, v180, v181
  v_cvt_pk_bf16_f32 v85, v182, v183
  v_cvt_pk_bf16_f32 v86, v184, v185
  v_cvt_pk_bf16_f32 v87, v186, v187
  v_cvt_pk_bf16_f32 v88, v188, v189
  v_cvt_pk_bf16_f32 v89, v190, v191
  v_cvt_pk_bf16_f32 v90, v192, v193
  v_cvt_pk_bf16_f32 v91, v194, v195
  buffer_store_dwordx4 v[84:87], v3, s[12:15], s75 offen offset:0 sc1
  buffer_store_dwordx4 v[88:91], v3, s[12:15], s75 offen offset:1024 sc1
  v_pk_mul_f32 v[68:69], v[196:197], v[196:197]
  v_pk_mul_f32 v[70:71], v[198:199], v[198:199]
  v_pk_mul_f32 v[72:73], v[200:201], v[200:201]
  v_pk_mul_f32 v[74:75], v[202:203], v[202:203]
  v_pk_mul_f32 v[76:77], v[204:205], v[204:205]
  v_pk_mul_f32 v[78:79], v[206:207], v[206:207]
  v_pk_mul_f32 v[80:81], v[208:209], v[208:209]
  v_pk_mul_f32 v[82:83], v[210:211], v[210:211]
  v_pk_fma_f32 v[68:69], v[68:69], v[144:145], v[142:143]
  v_pk_fma_f32 v[70:71], v[70:71], v[144:145], v[142:143]
  v_pk_fma_f32 v[72:73], v[72:73], v[144:145], v[142:143]
  v_pk_fma_f32 v[74:75], v[74:75], v[144:145], v[142:143]
  v_pk_fma_f32 v[76:77], v[76:77], v[144:145], v[142:143]
  v_pk_fma_f32 v[78:79], v[78:79], v[144:145], v[142:143]
  v_pk_fma_f32 v[80:81], v[80:81], v[144:145], v[142:143]
  v_pk_fma_f32 v[82:83], v[82:83], v[144:145], v[142:143]
  v_pk_mul_f32 v[68:69], v[68:69], v[196:197]
  v_pk_mul_f32 v[70:71], v[70:71], v[198:199]
  v_pk_mul_f32 v[72:73], v[72:73], v[200:201]
  v_pk_mul_f32 v[74:75], v[74:75], v[202:203]
  v_pk_mul_f32 v[76:77], v[76:77], v[204:205]
  v_pk_mul_f32 v[78:79], v[78:79], v[206:207]
  v_pk_mul_f32 v[80:81], v[80:81], v[208:209]
  v_pk_mul_f32 v[82:83], v[82:83], v[210:211]
  v_exp_f32 v68, v68
  v_exp_f32 v69, v69
  v_exp_f32 v70, v70
  v_exp_f32 v71, v71
  v_exp_f32 v72, v72
  v_exp_f32 v73, v73
  v_exp_f32 v74, v74
  v_exp_f32 v75, v75
  v_exp_f32 v76, v76
  v_exp_f32 v77, v77
  v_exp_f32 v78, v78
  v_exp_f32 v79, v79
  v_exp_f32 v80, v80
  v_exp_f32 v81, v81
  v_exp_f32 v82, v82
  v_exp_f32 v83, v83
  v_pk_fma_f32 v[68:69], v[68:69], v[140:141], v[140:141]
  v_pk_fma_f32 v[70:71], v[70:71], v[140:141], v[140:141]
  v_pk_fma_f32 v[72:73], v[72:73], v[140:141], v[140:141]
  v_pk_fma_f32 v[74:75], v[74:75], v[140:141], v[140:141]
  v_pk_fma_f32 v[76:77], v[76:77], v[140:141], v[140:141]
  v_pk_fma_f32 v[78:79], v[78:79], v[140:141], v[140:141]
  v_pk_fma_f32 v[80:81], v[80:81], v[140:141], v[140:141]
  v_pk_fma_f32 v[82:83], v[82:83], v[140:141], v[140:141]
  v_rcp_f32 v68, v68
  v_rcp_f32 v69, v69
  v_rcp_f32 v70, v70
  v_rcp_f32 v71, v71
  v_rcp_f32 v72, v72
  v_rcp_f32 v73, v73
  v_rcp_f32 v74, v74
  v_rcp_f32 v75, v75
  v_rcp_f32 v76, v76
  v_rcp_f32 v77, v77
  v_rcp_f32 v78, v78
  v_rcp_f32 v79, v79
  v_rcp_f32 v80, v80
  v_rcp_f32 v81, v81
  v_rcp_f32 v82, v82
  v_rcp_f32 v83, v83
  v_pk_mul_f32 v[196:197], v[196:197], v[68:69]
  v_pk_mul_f32 v[198:199], v[198:199], v[70:71]
  v_pk_mul_f32 v[200:201], v[200:201], v[72:73]
  v_pk_mul_f32 v[202:203], v[202:203], v[74:75]
  v_pk_mul_f32 v[204:205], v[204:205], v[76:77]
  v_pk_mul_f32 v[206:207], v[206:207], v[78:79]
  v_pk_mul_f32 v[208:209], v[208:209], v[80:81]
  v_pk_mul_f32 v[210:211], v[210:211], v[82:83]
  v_cvt_pk_bf16_f32 v92, v196, v197
  v_cvt_pk_bf16_f32 v93, v198, v199
  v_cvt_pk_bf16_f32 v94, v200, v201
  v_cvt_pk_bf16_f32 v95, v202, v203
  v_cvt_pk_bf16_f32 v96, v204, v205
  v_cvt_pk_bf16_f32 v97, v206, v207
  v_cvt_pk_bf16_f32 v98, v208, v209
  v_cvt_pk_bf16_f32 v99, v210, v211
  buffer_store_dwordx4 v[92:95], v3, s[12:15], s75 offen offset:2048 sc1
  buffer_store_dwordx4 v[96:99], v3, s[12:15], s75 offen offset:3072 sc1
  v_pk_mul_f32 v[52:53], v[212:213], v[212:213]
  v_pk_mul_f32 v[54:55], v[214:215], v[214:215]
  v_pk_mul_f32 v[56:57], v[216:217], v[216:217]
  v_pk_mul_f32 v[58:59], v[218:219], v[218:219]
  v_pk_mul_f32 v[60:61], v[220:221], v[220:221]
  v_pk_mul_f32 v[62:63], v[222:223], v[222:223]
  v_pk_mul_f32 v[64:65], v[224:225], v[224:225]
  v_pk_mul_f32 v[66:67], v[226:227], v[226:227]
  v_pk_fma_f32 v[52:53], v[52:53], v[144:145], v[142:143]
  v_pk_fma_f32 v[54:55], v[54:55], v[144:145], v[142:143]
  v_pk_fma_f32 v[56:57], v[56:57], v[144:145], v[142:143]
  v_pk_fma_f32 v[58:59], v[58:59], v[144:145], v[142:143]
  v_pk_fma_f32 v[60:61], v[60:61], v[144:145], v[142:143]
  v_pk_fma_f32 v[62:63], v[62:63], v[144:145], v[142:143]
  v_pk_fma_f32 v[64:65], v[64:65], v[144:145], v[142:143]
  v_pk_fma_f32 v[66:67], v[66:67], v[144:145], v[142:143]
  v_pk_mul_f32 v[52:53], v[52:53], v[212:213]
  v_pk_mul_f32 v[54:55], v[54:55], v[214:215]
  v_pk_mul_f32 v[56:57], v[56:57], v[216:217]
  v_pk_mul_f32 v[58:59], v[58:59], v[218:219]
  v_pk_mul_f32 v[60:61], v[60:61], v[220:221]
  v_pk_mul_f32 v[62:63], v[62:63], v[222:223]
  v_pk_mul_f32 v[64:65], v[64:65], v[224:225]
  v_pk_mul_f32 v[66:67], v[66:67], v[226:227]
  v_exp_f32 v52, v52
  v_exp_f32 v53, v53
  v_exp_f32 v54, v54
  v_exp_f32 v55, v55
  v_exp_f32 v56, v56
  v_exp_f32 v57, v57
  v_exp_f32 v58, v58
  v_exp_f32 v59, v59
  v_exp_f32 v60, v60
  v_exp_f32 v61, v61
  v_exp_f32 v62, v62
  v_exp_f32 v63, v63
  v_exp_f32 v64, v64
  v_exp_f32 v65, v65
  v_exp_f32 v66, v66
  v_exp_f32 v67, v67
  v_pk_fma_f32 v[52:53], v[52:53], v[140:141], v[140:141]
  v_pk_fma_f32 v[54:55], v[54:55], v[140:141], v[140:141]
  v_pk_fma_f32 v[56:57], v[56:57], v[140:141], v[140:141]
  v_pk_fma_f32 v[58:59], v[58:59], v[140:141], v[140:141]
  v_pk_fma_f32 v[60:61], v[60:61], v[140:141], v[140:141]
  v_pk_fma_f32 v[62:63], v[62:63], v[140:141], v[140:141]
  v_pk_fma_f32 v[64:65], v[64:65], v[140:141], v[140:141]
  v_pk_fma_f32 v[66:67], v[66:67], v[140:141], v[140:141]
  v_rcp_f32 v52, v52
  v_rcp_f32 v53, v53
  v_rcp_f32 v54, v54
  v_rcp_f32 v55, v55
  v_rcp_f32 v56, v56
  v_rcp_f32 v57, v57
  v_rcp_f32 v58, v58
  v_rcp_f32 v59, v59
  v_rcp_f32 v60, v60
  v_rcp_f32 v61, v61
  v_rcp_f32 v62, v62
  v_rcp_f32 v63, v63
  v_rcp_f32 v64, v64
  v_rcp_f32 v65, v65
  v_rcp_f32 v66, v66
  v_rcp_f32 v67, v67
  v_pk_mul_f32 v[212:213], v[212:213], v[52:53]
  v_pk_mul_f32 v[214:215], v[214:215], v[54:55]
  v_pk_mul_f32 v[216:217], v[216:217], v[56:57]
  v_pk_mul_f32 v[218:219], v[218:219], v[58:59]
  v_pk_mul_f32 v[220:221], v[220:221], v[60:61]
  v_pk_mul_f32 v[222:223], v[222:223], v[62:63]
  v_pk_mul_f32 v[224:225], v[224:225], v[64:65]
  v_pk_mul_f32 v[226:227], v[226:227], v[66:67]
  v_cvt_pk_bf16_f32 v100, v212, v213
  v_cvt_pk_bf16_f32 v101, v214, v215
  v_cvt_pk_bf16_f32 v102, v216, v217
  v_cvt_pk_bf16_f32 v103, v218, v219
  v_cvt_pk_bf16_f32 v104, v220, v221
  v_cvt_pk_bf16_f32 v105, v222, v223
  v_cvt_pk_bf16_f32 v106, v224, v225
  v_cvt_pk_bf16_f32 v107, v226, v227
  s_add_u32 s75, s75, 4096
  buffer_store_dwordx4 v[100:103], v3, s[12:15], s75 offen offset:0 sc1
  buffer_store_dwordx4 v[104:107], v3, s[12:15], s75 offen offset:1024 sc1
  v_pk_mul_f32 v[68:69], v[228:229], v[228:229]
  v_pk_mul_f32 v[70:71], v[230:231], v[230:231]
  v_pk_mul_f32 v[72:73], v[232:233], v[232:233]
  v_pk_mul_f32 v[74:75], v[234:235], v[234:235]
  v_pk_mul_f32 v[76:77], v[236:237], v[236:237]
  v_pk_mul_f32 v[78:79], v[238:239], v[238:239]
  v_pk_mul_f32 v[80:81], v[240:241], v[240:241]
  v_pk_mul_f32 v[82:83], v[242:243], v[242:243]
  v_pk_fma_f32 v[68:69], v[68:69], v[144:145], v[142:143]
  v_pk_fma_f32 v[70:71], v[70:71], v[144:145], v[142:143]
  v_pk_fma_f32 v[72:73], v[72:73], v[144:145], v[142:143]
  v_pk_fma_f32 v[74:75], v[74:75], v[144:145], v[142:143]
  v_pk_fma_f32 v[76:77], v[76:77], v[144:145], v[142:143]
  v_pk_fma_f32 v[78:79], v[78:79], v[144:145], v[142:143]
  v_pk_fma_f32 v[80:81], v[80:81], v[144:145], v[142:143]
  v_pk_fma_f32 v[82:83], v[82:83], v[144:145], v[142:143]
  v_pk_mul_f32 v[68:69], v[68:69], v[228:229]
  v_pk_mul_f32 v[70:71], v[70:71], v[230:231]
  v_pk_mul_f32 v[72:73], v[72:73], v[232:233]
  v_pk_mul_f32 v[74:75], v[74:75], v[234:235]
  v_pk_mul_f32 v[76:77], v[76:77], v[236:237]
  v_pk_mul_f32 v[78:79], v[78:79], v[238:239]
  v_pk_mul_f32 v[80:81], v[80:81], v[240:241]
  v_pk_mul_f32 v[82:83], v[82:83], v[242:243]
  v_exp_f32 v68, v68
  v_exp_f32 v69, v69
  v_exp_f32 v70, v70
  v_exp_f32 v71, v71
  v_exp_f32 v72, v72
  v_exp_f32 v73, v73
  v_exp_f32 v74, v74
  v_exp_f32 v75, v75
  v_exp_f32 v76, v76
  v_exp_f32 v77, v77
  v_exp_f32 v78, v78
  v_exp_f32 v79, v79
  v_exp_f32 v80, v80
  v_exp_f32 v81, v81
  v_exp_f32 v82, v82
  v_exp_f32 v83, v83
  v_pk_fma_f32 v[68:69], v[68:69], v[140:141], v[140:141]
  v_pk_fma_f32 v[70:71], v[70:71], v[140:141], v[140:141]
  v_pk_fma_f32 v[72:73], v[72:73], v[140:141], v[140:141]
  v_pk_fma_f32 v[74:75], v[74:75], v[140:141], v[140:141]
  v_pk_fma_f32 v[76:77], v[76:77], v[140:141], v[140:141]
  v_pk_fma_f32 v[78:79], v[78:79], v[140:141], v[140:141]
  v_pk_fma_f32 v[80:81], v[80:81], v[140:141], v[140:141]
  v_pk_fma_f32 v[82:83], v[82:83], v[140:141], v[140:141]
  v_rcp_f32 v68, v68
  v_rcp_f32 v69, v69
  v_rcp_f32 v70, v70
  v_rcp_f32 v71, v71
  v_rcp_f32 v72, v72
  v_rcp_f32 v73, v73
  v_rcp_f32 v74, v74
  v_rcp_f32 v75, v75
  v_rcp_f32 v76, v76
  v_rcp_f32 v77, v77
  v_rcp_f32 v78, v78
  v_rcp_f32 v79, v79
  v_rcp_f32 v80, v80
  v_rcp_f32 v81, v81
  v_rcp_f32 v82, v82
  v_rcp_f32 v83, v83
  v_pk_mul_f32 v[228:229], v[228:229], v[68:69]
  v_pk_mul_f32 v[230:231], v[230:231], v[70:71]
  v_pk_mul_f32 v[232:233], v[232:233], v[72:73]
  v_pk_mul_f32 v[234:235], v[234:235], v[74:75]
  v_pk_mul_f32 v[236:237], v[236:237], v[76:77]
  v_pk_mul_f32 v[238:239], v[238:239], v[78:79]
  v_pk_mul_f32 v[240:241], v[240:241], v[80:81]
  v_pk_mul_f32 v[242:243], v[242:243], v[82:83]
  v_cvt_pk_bf16_f32 v108, v228, v229
  v_cvt_pk_bf16_f32 v109, v230, v231
  v_cvt_pk_bf16_f32 v110, v232, v233
  v_cvt_pk_bf16_f32 v111, v234, v235
  v_cvt_pk_bf16_f32 v112, v236, v237
  v_cvt_pk_bf16_f32 v113, v238, v239
  v_cvt_pk_bf16_f32 v114, v240, v241
  v_cvt_pk_bf16_f32 v115, v242, v243
  buffer_store_dwordx4 v[108:111], v3, s[12:15], s75 offen offset:2048 sc1
  buffer_store_dwordx4 v[112:115], v3, s[12:15], s75 offen offset:3072 sc1
  s_waitcnt lgkmcnt(0)
  s_waitcnt vmcnt(0)
  s_barrier
  s_cmp_eq_u32 s20, 0
  s_cbranch_scc0 L_sig_25
  s_mul_i32 s25, s3, 80
  s_add_u32 s25, s25, 48
  s_add_u32 s25, s25, s60
  s_lshl_b32 s25, s25, 8
  v_mov_b32 v5, s25
  v_mov_b32 v6, 1
  s_mov_b64 exec, 1
  buffer_atomic_add v6, v5, s[52:55], 0 offen
  s_mov_b64 exec, -1
L_sig_25:
L_ffn1_skip:
  s_cmp_lt_u32 s22, 28
  s_cbranch_scc0 L_s4_skip
  s_lshl_b32 s64, s21, 2
  s_and_b32 s25, s22, 3
  s_add_u32 s64, s64, s25
  s_lshr_b32 s61, s22, 2
  s_lshr_b32 s60, s64, 1
  s_lshl_b32 s62, s64, 1
  s_lshr_b32 s25, s20, 1
  s_add_u32 s62, s62, s25
  s_lshl_b32 s63, s61, 1
  s_and_b32 s25, s20, 1
  s_add_u32 s63, s63, s25
  v_lshrrev_b32 v5, 3, v1
  v_and_b32 v6, 7, v1
  v_bfe_u32 v7, v1, 4, 1
  v_lshlrev_b32 v7, 2, v7
  v_xor_b32 v6, v6, v7
  v_mul_u32_u24 v248, 896, v5
  v_lshlrev_b32 v6, 4, v6
  v_add_u32 v248, v248, v6
  s_lshl_b32 s25, s61, 7
  v_add_u32 v248, s25, v248
  s_cmp_eq_u32 s3, 0
  s_cbranch_scc0 L_s4_skip
  s_lshl_b32 s65, s20, 10
  v_bfe_u32 v5, v1, 2, 2
  v_lshlrev_b32 v6, 2, v2
  v_add_u32 v6, v6, v5
  v_lshlrev_b32 v6, 7, v6
  v_and_b32 v7, 3, v1
  v_lshlrev_b32 v7, 3, v7
  v_add_u32 v6, v6, v7
  v_bfe_u32 v7, v1, 4, 1
  v_lshlrev_b32 v7, 5, v7
  v_add_u32 v6, v6, v7
  v_bfe_u32 v7, v1, 3, 1
  s_and_b32 s25, s20, 1
  v_xor_b32 v7, s25, v7
  v_lshlrev_b32 v7, 6, v7
  v_add_u32 v6, s65, v6
  v_add_u32 v249, v6, v7
  v_xor_b32 v7, 64, v7
  v_add_u32 v250, v6, v7
  s_add_u32 s84, s40, 0
  s_addc_u32 s85, s41, 0
  s_and_b32 s85, s85, 0xffff
  s_mov_b32 s86, 1605632
  s_mov_b32 s87, 0x20000
  s_mul_i32 s26, s20, 401408
  s_add_u32 m0, s65, 0
  s_add_u32 s27, s26, 243712
  buffer_load_dwordx4 v248, s[84:87], s27 offen lds
  s_add_u32 m0, s65, 4096
  s_add_u32 s27, s26, 250880
  buffer_load_dwordx4 v248, s[84:87], s27 offen lds
  s_add_u32 m0, s65, 8192
  s_add_u32 s27, s26, 258048
  buffer_load_dwordx4 v248, s[84:87], s27 offen lds
  s_add_u32 m0, s65, 12288
  s_add_u32 s27, s26, 265216
  buffer_load_dwordx4 v248, s[84:87], s27 offen lds
  s_add_u32 m0, s65, 16384
  s_add_u32 s27, s26, 272384
  buffer_load_dwordx4 v248, s[84:87], s27 offen lds
  s_add_u32 m0, s65, 20480
  s_add_u32 s27, s26, 279552
  buffer_load_dwordx4 v248, s[84:87], s27 offen lds
  s_add_u32 m0, s65, 24576
  s_add_u32 s27, s26, 286720
  buffer_load_dwordx4 v248, s[84:87], s27 offen lds
  s_add_u32 m0, s65, 28672
  s_add_u32 s27, s26, 293888
  buffer_load_dwordx4 v248, s[84:87], s27 offen lds
  s_add_u32 m0, s65, 32768
  s_add_u32 s27, s26, 301056
  buffer_load_dwordx4 v248, s[84:87], s27 offen lds
  s_add_u32 m0, s65, 36864
  s_add_u32 s27, s26, 308224
  buffer_load_dwordx4 v248, s[84:87], s27 offen lds
  s_add_u32 m0, s65, 40960
  s_add_u32 s27, s26, 315392
  buffer_load_dwordx4 v248, s[84:87], s27 offen lds
  s_add_u32 m0, s65, 45056
  s_add_u32 s27, s26, 322560
  buffer_load_dwordx4 v248, s[84:87], s27 offen lds
  s_add_u32 m0, s65, 49152
  s_add_u32 s27, s26, 329728
  buffer_load_dwordx4 v248, s[84:87], s27 offen lds
  s_add_u32 m0, s65, 53248
  s_add_u32 s27, s26, 336896
  buffer_load_dwordx4 v248, s[84:87], s27 offen lds
L_s4_skip:
  s_cmp_lt_u32 s22, 28
  s_nop 0
  s_cbranch_scc0 L_ffn2_skip
  s_lshl_b32 s64, s21, 2
  s_and_b32 s25, s22, 3
  s_add_u32 s64, s64, s25
  s_lshr_b32 s61, s22, 2
  s_lshr_b32 s60, s64, 1
  s_lshl_b32 s62, s64, 1
  s_lshr_b32 s25, s20, 1
  s_add_u32 s62, s62, s25
  s_lshl_b32 s63, s61, 1
  s_and_b32 s25, s20, 1
  s_add_u32 s63, s63, s25
  s_add_u32 s8, s42, 0
  s_addc_u32 s9, s43, 0
  s_and_b32 s9, s9, 0xffff
  s_mov_b32 s10, 896
  s_mov_b32 s11, 0x20000
  v_lshlrev_b32 v5, 3, v2
  s_lshl_b32 s25, s63, 6
  buffer_load_dwordx2 v[24:25], v5, s[8:11], s25 offen offset:0
  buffer_load_dwordx2 v[26:27], v5, s[8:11], s25 offen offset:16
  buffer_load_dwordx2 v[28:29], v5, s[8:11], s25 offen offset:32
  buffer_load_dwordx2 v[30:31], v5, s[8:11], s25 offen offset:48
  s_add_u32 s25, s72, 10485760
  s_add_u32 s4, s48, s25
  s_addc_u32 s5, s49, 0
  s_and_b32 s5, s5, 0xffff
  s_mov_b32 s6, 7340032
  s_mov_b32 s7, 0x20000
  s_mul_i32 s25, s20, 28
  s_mul_i32 s74, s62, 112
  s_add_u32 s74, s74, s25
  s_lshl_b32 s74, s74, 10
  s_xor_b32 s75, s62, 1
  s_mul_i32 s75, s75, 112
  s_add_u32 s75, s75, s25
  s_lshl_b32 s75, s75, 10
  s_mul_i32 s26, s62, 28672
  s_add_u32 s26, s26, s72
  s_add_u32 s26, s26, 8388608
  s_add_u32 s8, s48, s26
  s_addc_u32 s9, s49, 0
  s_and_b32 s9, s9, 0xffff
  s_mov_b32 s10, 28672
  s_mov_b32 s11, 0x20000
  s_cmp_eq_u32 s20, 0
  s_cbranch_scc0 L_wt_26
  s_mul_i32 s25, s3, 80
  s_add_u32 s25, s25, 48
  s_add_u32 s25, s25, s60
  s_lshl_b32 s25, s25, 8
  v_mov_b32 v5, s25
  s_mov_b32 s26, 0
  s_mov_b64 exec, 1
L_sp_27:
  v_mov_b32 v6, 0
  buffer_atomic_add v6, v5, s[52:55], 0 offen sc0
  s_waitcnt vmcnt(0)
  v_readfirstlane_b32 s25, v6
  s_add_u32 s26, s26, 1
  s_cmp_gt_u32 s26, 20000
  s_cbranch_scc1 L_wt_26x
  s_cmp_lt_u32 s25, 14
  s_cbranch_scc1 L_sp_27
L_wt_26x:
  s_mov_b64 exec, -1
L_wt_26:
  s_barrier
  buffer_load_dwordx4 v[32:35], v3, s[4:7], s74 offen offset:0 sc1
  buffer_load_dwordx4 v[36:39], v3, s[4:7], s75 offen offset:0 sc1
  buffer_load_dwordx4 v[40:43], v3, s[4:7], s74 offen offset:1024 sc1
  buffer_load_dwordx4 v[44:47], v3, s[4:7], s75 offen offset:1024 sc1
  buffer_load_dwordx4 v[48:51], v3, s[4:7], s74 offen offset:2048 sc1
  buffer_load_dwordx4 v[52:55], v3, s[4:7], s75 offen offset:2048 sc1
  buffer_load_dwordx4 v[56:59], v3, s[4:7], s74 offen offset:3072 sc1
  buffer_load_dwordx4 v[60:63], v3, s[4:7], s75 offen offset:3072 sc1
  s_add_u32 s74, s74, 4096
  s_add_u32 s75, s75, 4096
  buffer_load_dwordx4 v[64:67], v3, s[4:7], s74 offen offset:0 sc1
  buffer_load_dwordx4 v[68:71], v3, s[4:7], s75 offen offset:0 sc1
  buffer_load_dwordx4 v[72:75], v3, s[4:7], s74 offen offset:1024 sc1
  buffer_load_dwordx4 v[76:79], v3, s[4:7], s75 offen offset:1024 sc1
  buffer_load_dwordx4 v[80:83], v3, s[4:7], s74 offen offset:2048 sc1
  buffer_load_dwordx4 v[84:87], v3, s[4:7], s75 offen offset:2048 sc1
  buffer_load_dwordx4 v[88:91], v3, s[4:7], s74 offen offset:3072 sc1
  buffer_load_dwordx4 v[92:95], v3, s[4:7], s75 offen offset:3072 sc1
  s_add_u32 s74, s74, 4096
  s_add_u32 s75, s75, 4096
  buffer_load_dwordx4 v[96:99], v3, s[4:7], s74 offen offset:0 sc1
  buffer_load_dwordx4 v[100:103], v3, s[4:7], s75 offen offset:0 sc1
  buffer_load_dwordx4 v[104:107], v3, s[4:7], s74 offen offset:1024 sc1
  buffer_load_dwordx4 v[108:111], v3, s[4:7], s75 offen offset:1024 sc1
  buffer_load_dwordx4 v[112:115], v3, s[4:7], s74 offen offset:2048 sc1
  buffer_load_dwordx4 v[116:119], v3, s[4:7], s75 offen offset:2048 sc1
  buffer_load_dwordx4 v[120:123], v3, s[4:7], s74 offen offset:3072 sc1
  buffer_load_dwordx4 v[124:127], v3, s[4:7], s75 offen offset:3072 sc1
  s_add_u32 s74, s74, 4096
  s_add_u32 s75, s75, 4096
  buffer_load_dwordx4 v[128:131], v3, s[4:7], s74 offen offset:0 sc1
  buffer_load_dwordx4 v[132:135], v3, s[4:7], s75 offen offset:0 sc1
  buffer_load_dwordx4 v[136:139], v3, s[4:7], s74 offen offset:1024 sc1
  buffer_load_dwordx4 v[140:143], v3, s[4:7], s75 offen offset:1024 sc1
  s_lshl_b32 s25, s63, 11
  buffer_load_dwordx4 v[16:19], v3, s[8:11], s25 offen sc1
  buffer_load_dwordx4 v[20:23], v3, s[8:11], s25 offen offset:1024 sc1
  s_cmp_eq_u32 s3, 0
  s_cbranch_scc0 L_s4_nord
  s_waitcnt vmcnt(42)
  ds_read_b64_tr_b16 a[200:201], v249 offset:0
  ds_read_b64_tr_b16 a[202:203], v249 offset:4096
  ds_read_b64_tr_b16 a[204:205], v250 offset:0
  ds_read_b64_tr_b16 a[206:207], v250 offset:4096
  s_waitcnt vmcnt(40)
  ds_read_b64_tr_b16 a[208:209], v249 offset:8192
  ds_read_b64_tr_b16 a[210:211], v249 offset:12288
  ds_read_b64_tr_b16 a[212:213], v250 offset:8192
  ds_read_b64_tr_b16 a[214:215], v250 offset:12288
  s_waitcnt vmcnt(38)
  ds_read_b64_tr_b16 a[216:217], v249 offset:16384
  ds_read_b64_tr_b16 a[218:219], v249 offset:20480
  ds_read_b64_tr_b16 a[220:221], v250 offset:16384
  ds_read_b64_tr_b16 a[222:223], v250 offset:20480
  s_waitcnt vmcnt(36)
  ds_read_b64_tr_b16 a[224:225], v249 offset:24576
  ds_read_b64_tr_b16 a[226:227], v249 offset:28672
  ds_read_b64_tr_b16 a[228:229], v250 offset:24576
  ds_read_b64_tr_b16 a[230:231], v250 offset:28672
  s_waitcnt vmcnt(34)
  ds_read_b64_tr_b16 a[232:233], v249 offset:32768
  ds_read_b64_tr_b16 a[234:235], v249 offset:36864
  ds_read_b64_tr_b16 a[236:237], v250 offset:32768
  ds_read_b64_tr_b16 a[238:239], v250 offset:36864
  s_waitcnt vmcnt(32)
  ds_read_b64_tr_b16 a[240:241], v249 offset:40960
  ds_read_b64_tr_b16 a[242:243], v249 offset:45056
  ds_read_b64_tr_b16 a[244:245], v250 offset:40960
  ds_read_b64_tr_b16 a[246:247], v250 offset:45056
  s_waitcnt vmcnt(30)
  ds_read_b64_tr_b16 a[248:249], v249 offset:49152
  ds_read_b64_tr_b16 a[250:251], v249 offset:53248
  ds_read_b64_tr_b16 a[252:253], v250 offset:49152
  ds_read_b64_tr_b16 a[254:255], v250 offset:53248
  s_waitcnt lgkmcnt(0)
L_s4_nord:
  s_lshl_b32 s88, s20, 10
  s_add_u32 s88, s88, 81920
  v_bfe_u32 v5, v1, 2, 2
  v_lshlrev_b32 v6, 2, v2
  v_add_u32 v6, v6, v5
  v_lshlrev_b32 v6, 7, v6
  v_and_b32 v7, 3, v1
  v_lshlrev_b32 v7, 3, v7
  v_add_u32 v6, v6, v7
  v_bfe_u32 v7, v1, 4, 1
  v_lshlrev_b32 v7, 5, v7
  v_add_u32 v6, v6, v7
  v_bfe_u32 v7, v1, 3, 1
  s_and_b32 s25, s20, 1
  v_xor_b32 v7, s25, v7
  v_lshlrev_b32 v7, 6, v7
  v_add_u32 v6, s88, v6
  v_add_u32 v249, v6, v7
  v_xor_b32 v7, 64, v7
  v_add_u32 v250, v6, v7
  s_add_u32 s84, s40, 0
  s_addc_u32 s85, s41, 0
  s_and_b32 s85, s85, 0xffff
  s_mov_b32 s86, 1605632
  s_mov_b32 s87, 0x20000
  s_mul_i32 s65, s20, 401408
  s_waitcnt vmcnt(28)
  v_mfma_f32_32x32x16_bf16 v[144:159], a[64:67], v[32:35], 0
  v_mfma_f32_32x32x16_bf16 v[176:191], a[64:67], v[36:39], 0
  v_mfma_f32_32x32x16_bf16 v[160:175], a[68:71], v[32:35], 0
  v_mfma_f32_32x32x16_bf16 v[192:207], a[68:71], v[36:39], 0
  buffer_load_dwordx4 v[32:35], v3, s[4:7], s74 offen offset:2048 sc1
  buffer_load_dwordx4 v[36:39], v3, s[4:7], s75 offen offset:2048 sc1
  s_waitcnt vmcnt(28)
  v_mfma_f32_32x32x16_bf16 v[144:159], a[72:75], v[40:43], v[144:159]
  v_mfma_f32_32x32x16_bf16 v[176:191], a[72:75], v[44:47], v[176:191]
  v_mfma_f32_32x32x16_bf16 v[160:175], a[76:79], v[40:43], v[160:175]
  v_mfma_f32_32x32x16_bf16 v[192:207], a[76:79], v[44:47], v[192:207]
  buffer_load_dwordx4 v[40:43], v3, s[4:7], s74 offen offset:3072 sc1
  buffer_load_dwordx4 v[44:47], v3, s[4:7], s75 offen offset:3072 sc1
  s_add_u32 s74, s74, 4096
  s_add_u32 s75, s75, 4096
  s_waitcnt vmcnt(28)
  v_mfma_f32_32x32x16_bf16 v[144:159], a[80:83], v[48:51], v[144:159]
  v_mfma_f32_32x32x16_bf16 v[176:191], a[80:83], v[52:55], v[176:191]
  v_mfma_f32_32x32x16_bf16 v[160:175], a[84:87], v[48:51], v[160:175]
  v_mfma_f32_32x32x16_bf16 v[192:207], a[84:87], v[52:55], v[192:207]
  buffer_load_dwordx4 v[48:51], v3, s[4:7], s74 offen offset:0 sc1
  buffer_load_dwordx4 v[52:55], v3, s[4:7], s75 offen offset:0 sc1
  s_waitcnt vmcnt(28)
  v_mfma_f32_32x32x16_bf16 v[144:159], a[88:91], v[56:59], v[144:159]
  v_mfma_f32_32x32x16_bf16 v[176:191], a[88:91], v[60:63], v[176:191]
  v_mfma_f32_32x32x16_bf16 v[160:175], a[92:95], v[56:59], v[160:175]
  v_mfma_f32_32x32x16_bf16 v[192:207], a[92:95], v[60:63], v[192:207]
  buffer_load_dwordx4 v[56:59], v3, s[4:7], s74 offen offset:1024 sc1
  buffer_load_dwordx4 v[60:63], v3, s[4:7], s75 offen offset:1024 sc1
  s_waitcnt vmcnt(28)
  v_mfma_f32_32x32x16_bf16 v[144:159], a[96:99], v[64:67], v[144:159]
  v_mfma_f32_32x32x16_bf16 v[176:191], a[96:99], v[68:71], v[176:191]
  v_mfma_f32_32x32x16_bf16 v[160:175], a[100:103], v[64:67], v[160:175]
  v_mfma_f32_32x32x16_bf16 v[192:207], a[100:103], v[68:71], v[192:207]
  buffer_load_dwordx4 v[64:67], v3, s[4:7], s74 offen offset:2048 sc1
  buffer_load_dwordx4 v[68:71], v3, s[4:7], s75 offen offset:2048 sc1
  s_waitcnt vmcnt(28)
  v_mfma_f32_32x32x16_bf16 v[144:159], a[104:107], v[72:75], v[144:159]
  v_mfma_f32_32x32x16_bf16 v[176:191], a[104:107], v[76:79], v[176:191]
  v_mfma_f32_32x32x16_bf16 v[160:175], a[108:111], v[72:75], v[160:175]
  v_mfma_f32_32x32x16_bf16 v[192:207], a[108:111], v[76:79], v[192:207]
  buffer_load_dwordx4 v[72:75], v3, s[4:7], s74 offen offset:3072 sc1
  buffer_load_dwordx4 v[76:79], v3, s[4:7], s75 offen offset:3072 sc1
  s_add_u32 s74, s74, 4096
  s_add_u32 s75, s75, 4096
  s_waitcnt vmcnt(28)
  v_mfma_f32_32x32x16_bf16 v[144:159], a[112:115], v[80:83], v[144:159]
  v_mfma_f32_32x32x16_bf16 v[176:191], a[112:115], v[84:87], v[176:191]
  v_mfma_f32_32x32x16_bf16 v[160:175], a[116:119], v[80:83], v[160:175]
  v_mfma_f32_32x32x16_bf16 v[192:207], a[116:119], v[84:87], v[192:207]
  buffer_load_dwordx4 v[80:83], v3, s[4:7], s74 offen offset:0 sc1
  buffer_load_dwordx4 v[84:87], v3, s[4:7], s75 offen offset:0 sc1
  s_waitcnt vmcnt(28)
  v_mfma_f32_32x32x16_bf16 v[144:159], a[120:123], v[88:91], v[144:159]
  v_mfma_f32_32x32x16_bf16 v[176:191], a[120:123], v[92:95], v[176:191]
  v_mfma_f32_32x32x16_bf16 v[160:175], a[124:127], v[88:91], v[160:175]
  v_mfma_f32_32x32x16_bf16 v[192:207], a[124:127], v[92:95], v[192:207]
  buffer_load_dwordx4 v[88:91], v3, s[4:7], s74 offen offset:1024 sc1
  buffer_load_dwordx4 v[92:95], v3, s[4:7], s75 offen offset:1024 sc1
  s_waitcnt vmcnt(28)
  v_mfma_f32_32x32x16_bf16 v[144:159], a[128:131], v[96:99], v[144:159]
  v_mfma_f32_32x32x16_bf16 v[176:191], a[128:131], v[100:103], v[176:191]
  v_mfma_f32_32x32x16_bf16 v[160:175], a[132:135], v[96:99], v[160:175]
  v_mfma_f32_32x32x16_bf16 v[192:207], a[132:135], v[100:103], v[192:207]
  buffer_load_dwordx4 v[96:99], v3, s[4:7], s74 offen offset:2048 sc1
  buffer_load_dwordx4 v[100:103], v3, s[4:7], s75 offen offset:2048 sc1
  s_waitcnt vmcnt(28)
  v_mfma_f32_32x32x16_bf16 v[144:159], a[136:139], v[104:107], v[144:159]
  v_mfma_f32_32x32x16_bf16 v[176:191], a[136:139], v[108:111], v[176:191]
  v_mfma_f32_32x32x16_bf16 v[160:175], a[140:143], v[104:107], v[160:175]
  v_mfma_f32_32x32x16_bf16 v[192:207], a[140:143], v[108:111], v[192:207]
  buffer_load_dwordx4 v[104:107], v3, s[4:7], s74 offen offset:3072 sc1
  buffer_load_dwordx4 v[108:111], v3, s[4:7], s75 offen offset:3072 sc1
  s_add_u32 s74, s74, 4096
  s_add_u32 s75, s75, 4096
  s_waitcnt vmcnt(28)
  v_mfma_f32_32x32x16_bf16 v[144:159], a[144:147], v[112:115], v[144:159]
  v_mfma_f32_32x32x16_bf16 v[176:191], a[144:147], v[116:119], v[176:191]
  v_mfma_f32_32x32x16_bf16 v[160:175], a[148:151], v[112:115], v[160:175]
  v_mfma_f32_32x32x16_bf16 v[192:207], a[148:151], v[116:119], v[192:207]
  buffer_load_dwordx4 v[112:115], v3, s[4:7], s74 offen offset:0 sc1
  buffer_load_dwordx4 v[116:119], v3, s[4:7], s75 offen offset:0 sc1
  s_waitcnt vmcnt(28)
  v_mfma_f32_32x32x16_bf16 v[144:159], a[152:155], v[120:123], v[144:159]
  v_mfma_f32_32x32x16_bf16 v[176:191], a[152:155], v[124:127], v[176:191]
  v_mfma_f32_32x32x16_bf16 v[160:175], a[156:159], v[120:123], v[160:175]
  v_mfma_f32_32x32x16_bf16 v[192:207], a[156:159], v[124:127], v[192:207]
  buffer_load_dwordx4 v[120:123], v3, s[4:7], s74 offen offset:1024 sc1
  buffer_load_dwordx4 v[124:127], v3, s[4:7], s75 offen offset:1024 sc1
  s_waitcnt vmcnt(28)
  v_mfma_f32_32x32x16_bf16 v[144:159], a[160:163], v[128:131], v[144:159]
  v_mfma_f32_32x32x16_bf16 v[176:191], a[160:163], v[132:135], v[176:191]
  v_mfma_f32_32x32x16_bf16 v[160:175], a[164:167], v[128:131], v[160:175]
  v_mfma_f32_32x32x16_bf16 v[192:207], a[164:167], v[132:135], v[192:207]
  buffer_load_dwordx4 v[128:131], v3, s[4:7], s74 offen offset:2048 sc1
  buffer_load_dwordx4 v[132:135], v3, s[4:7], s75 offen offset:2048 sc1
  s_waitcnt vmcnt(28)
  v_mfma_f32_32x32x16_bf16 v[144:159], a[168:171], v[136:139], v[144:159]
  v_mfma_f32_32x32x16_bf16 v[176:191], a[168:171], v[140:143], v[176:191]
  v_mfma_f32_32x32x16_bf16 v[160:175], a[172:175], v[136:139], v[160:175]
  v_mfma_f32_32x32x16_bf16 v[192:207], a[172:175], v[140:143], v[192:207]
  buffer_load_dwordx4 v[136:139], v3, s[4:7], s74 offen offset:3072 sc1
  buffer_load_dwordx4 v[140:143], v3, s[4:7], s75 offen offset:3072 sc1
  s_add_u32 s74, s74, 4096
  s_add_u32 s75, s75, 4096
  s_waitcnt vmcnt(26)
  v_mfma_f32_32x32x16_bf16 v[144:159], a[176:179], v[32:35], v[144:159]
  v_mfma_f32_32x32x16_bf16 v[176:191], a[176:179], v[36:39], v[176:191]
  v_mfma_f32_32x32x16_bf16 v[160:175], a[180:183], v[32:35], v[160:175]
  v_mfma_f32_32x32x16_bf16 v[192:207], a[180:183], v[36:39], v[192:207]
  s_add_u32 m0, s88, 0
  s_add_u32 s27, s65, 344064
  buffer_load_dwordx4 v248, s[84:87], s27 offen lds
  s_add_u32 m0, s88, 4096
  s_add_u32 s27, s65, 351232
  buffer_load_dwordx4 v248, s[84:87], s27 offen lds
  s_waitcnt vmcnt(26)
  v_mfma_f32_32x32x16_bf16 v[144:159], a[184:187], v[40:43], v[144:159]
  v_mfma_f32_32x32x16_bf16 v[176:191], a[184:187], v[44:47], v[176:191]
  v_mfma_f32_32x32x16_bf16 v[160:175], a[188:191], v[40:43], v[160:175]
  v_mfma_f32_32x32x16_bf16 v[192:207], a[188:191], v[44:47], v[192:207]
  s_add_u32 m0, s88, 8192
  s_add_u32 s27, s65, 358400
  buffer_load_dwordx4 v248, s[84:87], s27 offen lds
  s_add_u32 m0, s88, 12288
  s_add_u32 s27, s65, 365568
  buffer_load_dwordx4 v248, s[84:87], s27 offen lds
  s_waitcnt vmcnt(26)
  v_mfma_f32_32x32x16_bf16 v[144:159], a[192:195], v[48:51], v[144:159]
  v_mfma_f32_32x32x16_bf16 v[176:191], a[192:195], v[52:55], v[176:191]
  v_mfma_f32_32x32x16_bf16 v[160:175], a[196:199], v[48:51], v[160:175]
  v_mfma_f32_32x32x16_bf16 v[192:207], a[196:199], v[52:55], v[192:207]
  s_add_u32 m0, s88, 16384
  s_add_u32 s27, s65, 372736
  buffer_load_dwordx4 v248, s[84:87], s27 offen lds
  s_add_u32 m0, s88, 20480
  s_add_u32 s27, s65, 379904
  buffer_load_dwordx4 v248, s[84:87], s27 offen lds
  s_waitcnt vmcnt(26)
  v_mfma_f32_32x32x16_bf16 v[144:159], a[200:203], v[56:59], v[144:159]
  v_mfma_f32_32x32x16_bf16 v[176:191], a[200:203], v[60:63], v[176:191]
  v_mfma_f32_32x32x16_bf16 v[160:175], a[204:207], v[56:59], v[160:175]
  v_mfma_f32_32x32x16_bf16 v[192:207], a[204:207], v[60:63], v[192:207]
  s_add_u32 m0, s88, 24576
  s_add_u32 s27, s65, 387072
  buffer_load_dwordx4 v248, s[84:87], s27 offen lds
  s_add_u32 m0, s88, 28672
  s_add_u32 s27, s65, 394240
  buffer_load_dwordx4 v248, s[84:87], s27 offen lds
  s_waitcnt vmcnt(26)
  v_mfma_f32_32x32x16_bf16 v[144:159], a[208:211], v[64:67], v[144:159]
  v_mfma_f32_32x32x16_bf16 v[176:191], a[208:211], v[68:71], v[176:191]
  v_mfma_f32_32x32x16_bf16 v[160:175], a[212:215], v[64:67], v[160:175]
  v_mfma_f32_32x32x16_bf16 v[192:207], a[212:215], v[68:71], v[192:207]
  s_waitcnt vmcnt(24)
  v_mfma_f32_32x32x16_bf16 v[144:159], a[216:219], v[72:75], v[144:159]
  v_mfma_f32_32x32x16_bf16 v[176:191], a[216:219], v[76:79], v[176:191]
  v_mfma_f32_32x32x16_bf16 v[160:175], a[220:223], v[72:75], v[160:175]
  v_mfma_f32_32x32x16_bf16 v[192:207], a[220:223], v[76:79], v[192:207]
  s_waitcnt vmcnt(6)
  ds_read_b64_tr_b16 v[216:217], v249 offset:0
  ds_read_b64_tr_b16 v[218:219], v249 offset:4096
  ds_read_b64_tr_b16 v[220:221], v250 offset:0
  ds_read_b64_tr_b16 v[222:223], v250 offset:4096
  s_waitcnt vmcnt(22)
  v_mfma_f32_32x32x16_bf16 v[144:159], a[224:227], v[80:83], v[144:159]
  v_mfma_f32_32x32x16_bf16 v[176:191], a[224:227], v[84:87], v[176:191]
  v_mfma_f32_32x32x16_bf16 v[160:175], a[228:231], v[80:83], v[160:175]
  v_mfma_f32_32x32x16_bf16 v[192:207], a[228:231], v[84:87], v[192:207]
  s_waitcnt vmcnt(4)
  ds_read_b64_tr_b16 v[224:225], v249 offset:8192
  ds_read_b64_tr_b16 v[226:227], v249 offset:12288
  ds_read_b64_tr_b16 v[228:229], v250 offset:8192
  ds_read_b64_tr_b16 v[230:231], v250 offset:12288
  s_waitcnt vmcnt(20)
  v_mfma_f32_32x32x16_bf16 v[144:159], a[232:235], v[88:91], v[144:159]
  v_mfma_f32_32x32x16_bf16 v[176:191], a[232:235], v[92:95], v[176:191]
  v_mfma_f32_32x32x16_bf16 v[160:175], a[236:239], v[88:91], v[160:175]
  v_mfma_f32_32x32x16_bf16 v[192:207], a[236:239], v[92:95], v[192:207]
  s_waitcnt vmcnt(2)
  ds_read_b64_tr_b16 v[232:233], v249 offset:16384
  ds_read_b64_tr_b16 v[234:235], v249 offset:20480
  ds_read_b64_tr_b16 v[236:237], v250 offset:16384
  ds_read_b64_tr_b16 v[238:239], v250 offset:20480
  s_waitcnt vmcnt(18)
  v_mfma_f32_32x32x16_bf16 v[144:159], a[240:243], v[96:99], v[144:159]
  v_mfma_f32_32x32x16_bf16 v[176:191], a[240:243], v[100:103], v[176:191]
  v_mfma_f32_32x32x16_bf16 v[160:175], a[244:247], v[96:99], v[160:175]
  v_mfma_f32_32x32x16_bf16 v[192:207], a[244:247], v[100:103], v[192:207]
  s_waitcnt vmcnt(0)
  ds_read_b64_tr_b16 v[240:241], v249 offset:24576
  ds_read_b64_tr_b16 v[242:243], v249 offset:28672
  ds_read_b64_tr_b16 v[244:245], v250 offset:24576
  ds_read_b64_tr_b16 v[246:247], v250 offset:28672
  s_waitcnt vmcnt(16)
  v_mfma_f32_32x32x16_bf16 v[144:159], a[248:251], v[104:107], v[144:159]
  v_mfma_f32_32x32x16_bf16 v[176:191], a[248:251], v[108:111], v[176:191]
  v_mfma_f32_32x32x16_bf16 v[160:175], a[252:255], v[104:107], v[160:175]
  v_mfma_f32_32x32x16_bf16 v[192:207], a[252:255], v[108:111], v[192:207]
  s_waitcnt lgkmcnt(0)
  s_waitcnt vmcnt(14)
  v_mfma_f32_32x32x16_bf16 v[144:159], v[216:219], v[112:115], v[144:159]
  v_mfma_f32_32x32x16_bf16 v[176:191], v[216:219], v[116:119], v[176:191]
  v_mfma_f32_32x32x16_bf16 v[160:175], v[220:223], v[112:115], v[160:175]
  v_mfma_f32_32x32x16_bf16 v[192:207], v[220:223], v[116:119], v[192:207]
  s_waitcnt vmcnt(12)
  v_mfma_f32_32x32x16_bf16 v[144:159], v[224:227], v[120:123], v[144:159]
  v_mfma_f32_32x32x16_bf16 v[176:191], v[224:227], v[124:127], v[176:191]
  v_mfma_f32_32x32x16_bf16 v[160:175], v[228:231], v[120:123], v[160:175]
  v_mfma_f32_32x32x16_bf16 v[192:207], v[228:231], v[124:127], v[192:207]
  s_waitcnt vmcnt(10)
  v_mfma_f32_32x32x16_bf16 v[144:159], v[232:235], v[128:131], v[144:159]
  v_mfma_f32_32x32x16_bf16 v[176:191], v[232:235], v[132:135], v[176:191]
  v_mfma_f32_32x32x16_bf16 v[160:175], v[236:239], v[128:131], v[160:175]
  v_mfma_f32_32x32x16_bf16 v[192:207], v[236:239], v[132:135], v[192:207]
  s_waitcnt vmcnt(8)
  v_mfma_f32_32x32x16_bf16 v[144:159], v[240:243], v[136:139], v[144:159]
  v_mfma_f32_32x32x16_bf16 v[176:191], v[240:243], v[140:143], v[176:191]
  v_mfma_f32_32x32x16_bf16 v[160:175], v[244:247], v[136:139], v[160:175]
  v_mfma_f32_32x32x16_bf16 v[192:207], v[244:247], v[140:143], v[192:207]
  s_xor_b32 s25, s20, 1
  s_mul_i32 s25, s25, 12288
  s_add_u32 s25, s25, 114688
  v_add_u32 v5, s25, v3
  s_xor_b32 s25, s20, 2
  s_mul_i32 s25, s25, 12288
  s_add_u32 s25, s25, 118784
  v_add_u32 v6, s25, v3
  s_xor_b32 s25, s20, 3
  s_mul_i32 s25, s25, 12288
  s_add_u32 s25, s25, 122880
  v_add_u32 v7, s25, v3
  ds_write_b128 v5, v[160:163] offset:0
  ds_write_b128 v5, v[164:167] offset:1024
  ds_write_b128 v5, v[168:171] offset:2048
  ds_write_b128 v5, v[172:175] offset:3072
  ds_write_b128 v6, v[176:179] offset:0
  ds_write_b128 v6, v[180:183] offset:1024
  ds_write_b128 v6, v[184:187] offset:2048
  ds_write_b128 v6, v[188:191] offset:3072
  ds_write_b128 v7, v[192:195] offset:0
  ds_write_b128 v7, v[196:199] offset:1024
  ds_write_b128 v7, v[200:203] offset:2048
  ds_write_b128 v7, v[204:207] offset:3072
  v_lshlrev_b32 v5, 16, v24
  v_and_b32 v6, 0xffff0000, v24
  v_add_f32 v144, v144, v5
  v_add_f32 v145, v145, v6
  v_lshlrev_b32 v7, 16, v25
  v_and_b32 v8, 0xffff0000, v25
  v_add_f32 v146, v146, v7
  v_add_f32 v147, v147, v8
  v_lshlrev_b32 v5, 16, v26
  v_and_b32 v6, 0xffff0000, v26
  v_add_f32 v148, v148, v5
  v_add_f32 v149, v149, v6
  v_lshlrev_b32 v7, 16, v27
  v_and_b32 v8, 0xffff0000, v27
  v_add_f32 v150, v150, v7
  v_add_f32 v151, v151, v8
  v_lshlrev_b32 v5, 16, v28
  v_and_b32 v6, 0xffff0000, v28
  v_add_f32 v152, v152, v5
  v_add_f32 v153, v153, v6
  v_lshlrev_b32 v7, 16, v29
  v_and_b32 v8, 0xffff0000, v29
  v_add_f32 v154, v154, v7
  v_add_f32 v155, v155, v8
  v_lshlrev_b32 v5, 16, v30
  v_and_b32 v6, 0xffff0000, v30
  v_add_f32 v156, v156, v5
  v_add_f32 v157, v157, v6
  v_lshlrev_b32 v7, 16, v31
  v_and_b32 v8, 0xffff0000, v31
  v_add_f32 v158, v158, v7
  v_add_f32 v159, v159, v8
  v_lshlrev_b32 v5, 16, v16
  v_and_b32 v6, 0xffff0000, v16
  v_add_f32 v144, v144, v5
  v_add_f32 v145, v145, v6
  v_lshlrev_b32 v7, 16, v17
  v_and_b32 v8, 0xffff0000, v17
  v_add_f32 v146, v146, v7
  v_add_f32 v147, v147, v8
  v_lshlrev_b32 v5, 16, v18
  v_and_b32 v6, 0xffff0000, v18
  v_add_f32 v148, v148, v5
  v_add_f32 v149, v149, v6
  v_lshlrev_b32 v7, 16, v19
  v_and_b32 v8, 0xffff0000, v19
  v_add_f32 v150, v150, v7
  v_add_f32 v151, v151, v8
  v_lshlrev_b32 v5, 16, v20
  v_and_b32 v6, 0xffff0000, v20
  v_add_f32 v152, v152, v5
  v_add_f32 v153, v153, v6
  v_lshlrev_b32 v7, 16, v21
  v_and_b32 v8, 0xffff0000, v21
  v_add_f32 v154, v154, v7
  v_add_f32 v155, v155, v8
  v_lshlrev_b32 v5, 16, v22
  v_and_b32 v6, 0xffff0000, v22
  v_add_f32 v156, v156, v5
  v_add_f32 v157, v157, v6
  v_lshlrev_b32 v7, 16, v23
  v_and_b32 v8, 0xffff0000, v23
  v_add_f32 v158, v158, v7
  v_add_f32 v159, v159, v8
  s_mul_i32 s25, s20, 12288
  s_add_u32 s25, s25, 114688
  v_add_u32 v5, s25, v3
  s_waitcnt lgkmcnt(0)
  s_barrier
  ds_read_b128 v[160:163], v5 offset:0
  ds_read_b128 v[164:167], v5 offset:1024
  ds_read_b128 v[168:171], v5 offset:2048
  ds_read_b128 v[172:175], v5 offset:3072
  ds_read_b128 v[176:179], v5 offset:4096
  ds_read_b128 v[180:183], v5 offset:5120
  ds_read_b128 v[184:187], v5 offset:6144
  ds_read_b128 v[188:191], v5 offset:7168
  ds_read_b128 v[192:195], v5 offset:8192
  ds_read_b128 v[196:199], v5 offset:9216
  ds_read_b128 v[200:203], v5 offset:10240
  ds_read_b128 v[204:207], v5 offset:11264
  s_waitcnt lgkmcnt(8)
  v_pk_add_f32 v[144:145], v[144:145], v[160:161]
  v_pk_add_f32 v[146:147], v[146:147], v[162:163]
  v_pk_add_f32 v[148:149], v[148:149], v[164:165]
  v_pk_add_f32 v[150:151], v[150:151], v[166:167]
  v_pk_add_f32 v[152:153], v[152:153], v[168:169]
  v_pk_add_f32 v[154:155], v[154:155], v[170:171]
  v_pk_add_f32 v[156:157], v[156:157], v[172:173]
  v_pk_add_f32 v[158:159], v[158:159], v[174:175]
  s_waitcnt lgkmcnt(4)
  v_pk_add_f32 v[144:145], v[144:145], v[176:177]
  v_pk_add_f32 v[146:147], v[146:147], v[178:179]
  v_pk_add_f32 v[148:149], v[148:149], v[180:181]
  v_pk_add_f32 v[150:151], v[150:151], v[182:183]
  v_pk_add_f32 v[152:153], v[152:153], v[184:185]
  v_pk_add_f32 v[154:155], v[154:155], v[186:187]
  v_pk_add_f32 v[156:157], v[156:157], v[188:189]
  v_pk_add_f32 v[158:159], v[158:159], v[190:191]
  s_waitcnt lgkmcnt(0)
  v_pk_add_f32 v[144:145], v[144:145], v[192:193]
  v_pk_add_f32 v[146:147], v[146:147], v[194:195]
  v_pk_add_f32 v[148:149], v[148:149], v[196:197]
  v_pk_add_f32 v[150:151], v[150:151], v[198:199]
  v_pk_add_f32 v[152:153], v[152:153], v[200:201]
  v_pk_add_f32 v[154:155], v[154:155], v[202:203]
  v_pk_add_f32 v[156:157], v[156:157], v[204:205]
  v_pk_add_f32 v[158:159], v[158:159], v[206:207]
  s_cmp_eq_u32 s3, 1
  s_cbranch_scc1 L_final
  s_mov_b32 s74, 17825792
  s_mov_b32 s75, 20185088
  v_cvt_pk_bf16_f32 v208, v144, v145
  v_cvt_pk_bf16_f32 v209, v146, v147
  v_cvt_pk_bf16_f32 v210, v148, v149
  v_cvt_pk_bf16_f32 v211, v150, v151
  v_cvt_pk_bf16_f32 v212, v152, v153
  v_cvt_pk_bf16_f32 v213, v154, v155
  v_cvt_pk_bf16_f32 v214, v156, v157
  v_cvt_pk_bf16_f32 v215, v158, v159
  s_mul_i32 s25, s62, 28672
  s_add_u32 s25, s25, s74
  s_add_u32 s12, s48, s25
  s_addc_u32 s13, s49, 0
  s_and_b32 s13, s13, 0xffff
  s_mov_b32 s14, 28672
  s_mov_b32 s15, 0x20000
  s_lshl_b32 s25, s63, 11
  buffer_store_dwordx4 v[208:211], v3, s[12:15], s25 offen sc1
  buffer_store_dwordx4 v[212:215], v3, s[12:15], s25 offen offset:1024 sc1
  v_pk_add_f32 v[160:161], v[144:145], v[146:147]
  v_pk_mul_f32 v[162:163], v[144:145], v[144:145]
  v_pk_fma_f32 v[162:163], v[146:147], v[146:147], v[162:163]
  v_pk_add_f32 v[160:161], v[160:161], v[148:149]
  v_pk_fma_f32 v[162:163], v[148:149], v[148:149], v[162:163]
  v_pk_add_f32 v[160:161], v[160:161], v[150:151]
  v_pk_fma_f32 v[162:163], v[150:151], v[150:151], v[162:163]
  v_pk_add_f32 v[160:161], v[160:161], v[152:153]
  v_pk_fma_f32 v[162:163], v[152:153], v[152:153], v[162:163]
  v_pk_add_f32 v[160:161], v[160:161], v[154:155]
  v_pk_fma_f32 v[162:163], v[154:155], v[154:155], v[162:163]
  v_pk_add_f32 v[160:161], v[160:161], v[156:157]
  v_pk_fma_f32 v[162:163], v[156:157], v[156:157], v[162:163]
  v_pk_add_f32 v[160:161], v[160:161], v[158:159]
  v_pk_fma_f32 v[162:163], v[158:159], v[158:159], v[162:163]
  v_add_f32 v12, v160, v161
  v_add_f32 v13, v162, v163
  v_mov_b32 v5, v12
  s_nop 1
  v_permlane32_swap_b32 v12, v5
  v_add_f32 v12, v12, v5
  v_mov_b32 v6, v13
  s_nop 1
  v_permlane32_swap_b32 v13, v6
  v_add_f32 v13, v13, v6
  s_mul_i32 s25, s62, 14
  s_add_u32 s25, s25, s63
  s_lshl_b32 s25, s25, 8
  s_add_u32 s25, s25, s75
  s_add_u32 s16, s48, s25
  s_addc_u32 s17, s49, 0
  s_and_b32 s17, s17, 0xffff
  s_mov_b32 s18, 256
  s_mov_b32 s19, 0x20000
  v_lshlrev_b32 v5, 3, v4
  buffer_store_dwordx2 v[12:13], v5, s[16:19], 0 offen sc1
  s_waitcnt vmcnt(0)
  s_barrier
  s_cmp_eq_u32 s20, 0
  s_cbranch_scc0 L_sig_28
  s_mul_i32 s25, s3, 80
  s_add_u32 s25, s25, 64
  s_add_u32 s25, s25, s60
  s_lshl_b32 s25, s25, 8
  v_mov_b32 v5, s25
  v_mov_b32 v6, 1
  s_mov_b64 exec, 1
  buffer_atomic_add v6, v5, s[52:55], 0 offen sc1
  s_mov_b64 exec, -1
L_sig_28:
  s_nop 0
  s_branch L_next_layer
L_ffn2_skip:
  s_cmp_eq_u32 s3, 1
  s_cbranch_scc1 L_fin2
L_next_layer:
  s_lshl_b32 s60, s23, 2
  s_and_b32 s25, s22, 3
  s_add_u32 s60, s60, s25
  s_lshl_b32 s61, s24, 3
  s_lshr_b32 s25, s22, 2
  s_add_u32 s61, s61, s25
  s_mul_i32 s26, s61, 114688
  s_add_u32 s26, s26, 41943040
  s_add_u32 s76, s48, s26
  s_addc_u32 s77, s49, 0
  s_and_b32 s77, s77, 0xffff
  s_mov_b32 s78, 114688
  s_mov_b32 s79, 0x20000
  s_lshl_b32 s58, s20, 10
  s_mov_b32 m0, s58
L_wi_29:
  s_nop 0
  buffer_load_dwordx4 v3, s[76:79], s58 offen lds
  s_add_u32 s58, s58, 4096
  s_add_u32 m0, m0, 4096
  s_cmp_lt_u32 s58, 114688
  s_cbranch_scc1 L_wi_29
  s_mov_b32 s3, 1
  s_mov_b32 s72, 20971520
  s_branch L_qkv
L_final:
  v_cvt_pk_bf16_f32 v208, v144, v145
  v_cvt_pk_bf16_f32 v209, v146, v147
  v_cvt_pk_bf16_f32 v210, v148, v149
  v_cvt_pk_bf16_f32 v211, v150, v151
  v_cvt_pk_bf16_f32 v212, v152, v153
  v_cvt_pk_bf16_f32 v213, v154, v155
  v_cvt_pk_bf16_f32 v214, v156, v157
  v_cvt_pk_bf16_f32 v215, v158, v159
  s_mul_i32 s27, s62, 28672
  s_add_u32 s12, s44, s27
  s_addc_u32 s13, s45, 0
  s_and_b32 s13, s13, 0xffff
  s_mov_b32 s14, 28672
  s_mov_b32 s15, 0x20000
  v_permlane32_swap_b32 v208, v210
  v_permlane32_swap_b32 v209, v211
  v_permlane32_swap_b32 v212, v214
  v_permlane32_swap_b32 v213, v215
  v_mul_u32_u24 v5, 896, v4
  v_lshl_add_u32 v5, v2, 4, v5
  s_lshl_b32 s25, s63, 6
  buffer_store_dwordx4 v[208:211], v5, s[12:15], s25 offen
  buffer_store_dwordx4 v[212:215], v5, s[12:15], s25 offen offset:32
L_fin2:
L_end:
  s_endpgm
L_att_slow:
  s_lshl_b32 s25, s20, 11
  s_add_u32 s25, s25, s66
  buffer_load_dwordx4 v[12:15], v3, s[4:7], s25 offen sc1
  buffer_load_dwordx4 v[16:19], v3, s[4:7], s25 offen offset:1024 sc1
  v_mov_b32 v8, 0
  s_waitcnt vmcnt(0)
  v_cndmask_b32 v18, v18, v8, s[50:51]
  v_cndmask_b32 v19, v19, v8, s[50:51]
  v_mov_b32 v7, 0xff800000
  s_lshl_b32 s74, s68, 17
  s_add_u32 s65, s74, 2097152
  s_mov_b32 s67, 0
L_att_slowA:
  buffer_load_dwordx4 v[44:47], v3, s[4:7], s65 offen sc1
  buffer_load_dwordx4 v[48:51], v3, s[4:7], s65 offen offset:1024 sc1
  s_add_u32 s65, s65, 2048
  s_waitcnt vmcnt(0)
  v_mfma_f32_32x32x16_bf16 v[108:123], v[44:47], v[12:15], 0
  v_mfma_f32_32x32x16_bf16 v[108:123], v[48:51], v[16:19], v[108:123]
  s_nop 11
  v_max3_f32 v7, v7, v108, v109
  v_max3_f32 v7, v7, v110, v111
  v_max3_f32 v7, v7, v112, v113
  v_max3_f32 v7, v7, v114, v115
  v_max3_f32 v7, v7, v116, v117
  v_max3_f32 v7, v7, v118, v119
  v_max3_f32 v7, v7, v120, v121
  v_max3_f32 v7, v7, v122, v123
  s_add_u32 s67, s67, 1
  s_cmp_lt_u32 s67, 64
  s_nop 13
  s_cbranch_scc1 L_att_slowA
  v_mov_b32 v5, v7
  s_nop 1
  v_permlane32_swap_b32 v7, v5
  v_max_f32 v7, v7, v5
  v_sub_f32 v7, 0, v7
  v_cvt_pk_bf16_f32 v5, v7, v7
  v_and_b32 v5, 0xffff0000, v5
  v_sub_f32 v6, v7, v5
  v_cvt_pk_bf16_f32 v220, v7, v6
  v_and_b32 v5, 0xffff0000, v220
  v_sub_f32 v6, v6, v5
  v_cvt_pk_bf16_f32 v221, v6, v8
  v_cndmask_b32 v18, v18, v220, s[50:51]
  v_cndmask_b32 v19, v19, v221, s[50:51]
  v_mov_b32 v156, 0
  v_mov_b32 v157, 0
  v_mov_b32 v158, 0
  v_mov_b32 v159, 0
  v_mov_b32 v160, 0
  v_mov_b32 v161, 0
  v_mov_b32 v162, 0
  v_mov_b32 v163, 0
  v_mov_b32 v164, 0
  v_mov_b32 v165, 0
  v_mov_b32 v166, 0
  v_mov_b32 v167, 0
  v_mov_b32 v168, 0
  v_mov_b32 v169, 0
  v_mov_b32 v170, 0
  v_mov_b32 v171, 0
  s_lshl_b32 s74, s68, 17
  s_add_u32 s65, s74, 2097152
  s_mov_b32 s67, 0
L_att_slowB:
  buffer_load_dwordx4 v[44:47], v3, s[4:7], s65 offen sc1
  buffer_load_dwordx4 v[48:51], v3, s[4:7], s65 offen offset:1024 sc1
  s_add_u32 s65, s65, 2048
  buffer_load_dwordx4 v[52:55], v3, s[8:11], s74 offen sc1
  buffer_load_dwordx4 v[56:59], v3, s[8:11], s74 offen offset:1024 sc1
  s_add_u32 s74, s74, 2048
  s_waitcnt vmcnt(0)
  v_mfma_f32_32x32x16_bf16 v[108:123], v[44:47], v[12:15], 0
  v_mfma_f32_32x32x16_bf16 v[108:123], v[48:51], v[16:19], v[108:123]
  s_nop 11
  v_exp_f32 v108, v108
  v_exp_f32 v109, v109
  v_exp_f32 v110, v110
  v_exp_f32 v111, v111
  v_cvt_pk_bf16_f32 v140, v108, v109
  v_exp_f32 v112, v112
  v_exp_f32 v113, v113
  v_cvt_pk_bf16_f32 v141, v110, v111
  v_exp_f32 v114, v114
  v_exp_f32 v115, v115
  v_cvt_pk_bf16_f32 v142, v112, v113
  v_exp_f32 v116, v116
  v_exp_f32 v117, v117
  v_cvt_pk_bf16_f32 v143, v114, v115
  v_exp_f32 v118, v118
  v_exp_f32 v119, v119
  v_cvt_pk_bf16_f32 v144, v116, v117
  v_exp_f32 v120, v120
  v_exp_f32 v121, v121
  v_cvt_pk_bf16_f32 v145, v118, v119
  v_exp_f32 v122, v122
  v_exp_f32 v123, v123
  v_cvt_pk_bf16_f32 v146, v120, v121
  v_cvt_pk_bf16_f32 v147, v122, v123
  v_mfma_f32_32x32x16_bf16 v[156:171], v[52:55], v[140:143], v[156:171]
  s_nop 0
  v_mfma_f32_32x32x16_bf16 v[156:171], v[56:59], v[144:147], v[156:171]
  s_add_u32 s67, s67, 1
  s_cmp_lt_u32 s67, 64
  s_nop 11
  s_cbranch_scc1 L_att_slowB
  v_mov_b32 v5, v168
  v_mov_b32 v6, v168
  s_nop 1
  v_permlane32_swap_b32 v5, v6
  s_nop 0
  s_branch L_att_fin
KEND:
.section .rodata,"a"
.p2align 6
.amdhsa_kernel interleave_layers__mha_block__dense_activation_gelu__prompt_kernel
  .amdhsa_next_free_vgpr 512
  .amdhsa_next_free_sgpr 96
  .amdhsa_accum_offset 256
  .amdhsa_group_segment_fixed_size 0
  .amdhsa_kernarg_size 88
  .amdhsa_user_sgpr_count 2
  .amdhsa_user_sgpr_kernarg_segment_ptr 1
  .amdhsa_system_sgpr_workgroup_id_x 1
.end_amdhsa_kernel
```
